```python
import torch

def _softmax(x, axis=-1):
    return torch.softmax(x, dim=axis)
def _gelu(x):
    return torch.nn.functional.gelu(x, approximate="tanh")
def _silu(x):
    return torch.nn.functional.silu(x)
def _sigmoid(x):
    return torch.sigmoid(x)
def _layernorm(x, axis=-1, eps=1e-5):
    m = x.mean(dim=axis, keepdim=True)
    v = x.var(dim=axis, keepdim=True, unbiased=False)
    return (x - m) / torch.sqrt(v + eps)
def _scatter_add(tgt, idx, src, axis=0):
    return tgt.clone().index_add_(axis, idx, src)
def _segment_sum(src, seg, n):
    out = torch.zeros((n,) + src.shape[1:], dtype=src.dtype)
    return out.index_add_(0, seg, src)
def _pad(x, pw):
    flat = tuple(v for pair in reversed(pw) for v in pair)
    return torch.nn.functional.pad(x, flat)

kernel_name = 'gated_mix__ssm_conv_s4__dense_activation_mish__prompt'

def setup_inputs():

    _w = (lambda a: (lambda t: t.to(torch.bfloat16) if t.is_floating_point() else t)(torch.as_tensor(a)))
    def _A_setup():
        B, L, D, N = 1, 2048, 512, 128
        A_re = -(lambda _x: torch.exp(torch.as_tensor(_x)))((lambda *s: torch.randn(*s, dtype=torch.bfloat16) * 6.4)(D, N))
        A_im = torch.pi * (lambda *s: torch.randn(*s, dtype=torch.bfloat16) * 0.05)(D, N)
        B_re = (lambda *s: torch.randn(*s, dtype=torch.bfloat16) * 0.1)(D, N)
        B_im = (lambda *s: torch.randn(*s, dtype=torch.bfloat16) * 0.1)(D, N)
        C_re = (lambda *s: torch.randn(*s, dtype=torch.bfloat16) * 0.1)(D, N)
        C_im = (lambda *s: torch.randn(*s, dtype=torch.bfloat16) * 0.1)(D, N)
        log_dt = (lambda *s: torch.randn(*s, dtype=torch.bfloat16) * 0.05)(D) * 0.5 - 4.0
        Dskip = (lambda *s: torch.randn(*s, dtype=torch.bfloat16) * 0.05)(D)
        return {
            "u": _w((lambda *s: torch.randn(*s, dtype=torch.bfloat16) * 0.05)(B, L, D)),
            "A_re": _w(A_re),
            "A_im": _w(A_im),
            "B_re": _w(B_re),
            "B_im": _w(B_im),
            "C_re": _w(C_re),
            "C_im": _w(C_im),
            "log_dt": _w(log_dt),
            "Dskip": _w(Dskip),
        }
    _A_in = _A_setup()

    def _B_setup():
        B, S, D, F = 1, 2048, 512, 1792
        return {
            "x": _w((lambda *s: torch.randn(*s, dtype=torch.bfloat16) * 0.05)(B, S, D)),
            "w1": _w((lambda *s: torch.randn(*s, dtype=torch.bfloat16) * 6.4)(D, F) * (D ** -0.5)),
            "b1": _w((lambda *s: torch.randn(*s, dtype=torch.bfloat16) * 0.05)(F)),
            "w2": _w((lambda *s: torch.randn(*s, dtype=torch.bfloat16) * 0.05)(F, D) * (F ** -0.5)),
        }
    _B_in = _B_setup()

    return {
        "A_u": _A_in["u"],
        "A_A_re": _A_in["A_re"],
        "A_A_im": _A_in["A_im"],
        "A_B_re": _A_in["B_re"],
        "A_B_im": _A_in["B_im"],
        "A_C_re": _A_in["C_re"],
        "A_C_im": _A_in["C_im"],
        "A_log_dt": _A_in["log_dt"],
        "A_Dskip": _A_in["Dskip"],
        "B_x": _B_in["x"],
        "B_w1": _B_in["w1"],
        "B_b1": _B_in["b1"],
        "B_w2": _B_in["w2"],
        "gate_w": _w((lambda *s: torch.randn(*s, dtype=torch.bfloat16) * 0.05)(512) * 16.0),
    }

def reference(A_u, A_A_re, A_A_im, A_B_re, A_B_im, A_C_re, A_C_im, A_log_dt, A_Dskip, B_x, B_w1, B_b1, B_w2, gate_w):
    def _A_ref(u, A_re, A_im, B_re, B_im, C_re, C_im, log_dt, Dskip):
        Bsz, L, D = u.shape
        dt = torch.exp(log_dt)[:, None]
        A = A_re + 1j * A_im
        Bc = B_re + 1j * B_im
        Cc = C_re + 1j * C_im
        logdA = dt * A
        dB = dt * Bc
        l = (lambda x, dt: x.to(dt))(torch.arange(L), A_re.dtype)
        P = torch.exp(logdA[:, :, None] * l[None, None, :])
        K = torch.einsum("dn,dnl,dn->dl", Cc, P, dB).real
        L2 = 2 * L
        Kp = _pad(K, ((0, 0), (0, L)))
        up = (lambda x, *d: x.permute(*d))(u, 0, 2, 1)
        up = _pad(up, ((0, 0), (0, 0), (0, L)))
        Kf = (lambda x, axes=(-2,-1): torch.fft.rfft2(x.float(), dim=axes))(Kp[:, None, :], axes=(-2, -1))
        Uf = (lambda x, axes=(-2,-1): torch.fft.rfft2(x.float(), dim=axes))(up[:, :, None, :], axes=(-2, -1))
        Yf = Uf * Kf[None, :, :, :]
        y = (lambda x, s, axes=(-2,-1): torch.fft.irfft2(x, s=s, dim=axes).to(torch.bfloat16))(Yf, (1, L2), axes=(-2, -1))[:, :, 0, :L]
        y = (lambda x, *d: x.permute(*d))(y, 0, 2, 1) + u * Dskip[None, None, :]
        return y

    def _B_ref(x, w1, b1, w2):
        h = torch.einsum("bsd,df->bsf", x, w1) + b1
        sp = torch.log1p(torch.exp(-torch.abs(h))) + torch.where(h > 0, h, torch.zeros_like(h))
        act = h * torch.tanh(sp)
        return torch.einsum("bsf,fd->bsd", act, w2)

    x = A_u
    g = _sigmoid((x * gate_w).sum(-1, keepdims=True))
    a = _A_ref(x, A_A_re, A_A_im, A_B_re, A_B_im, A_C_re, A_C_im, A_log_dt, A_Dskip)
    b = _B_ref(x, B_w1, B_b1, B_w2)
    return g * a + (1 - g) * b
```

```asm
; @launch grid=(256,1,1) block=(512,1,1) lds=163840
.amdgcn_target "amdgcn-amd-amdhsa--gfx950"
.text
.globl gated_mix__ssm_conv_s4__dense_activation_mish__prompt_kernel
.p2align 8
.type gated_mix__ssm_conv_s4__dense_activation_mish__prompt_kernel,@function
gated_mix__ssm_conv_s4__dense_activation_mish__prompt_kernel:
  s_cmp_ge_u32 s2, 256
  s_cbranch_scc1 L_end
  s_load_dwordx16 s[4:19], s[0:1], 0
  s_load_dwordx16 s[20:35], s[0:1], 64
  s_load_dwordx2 s[36:37], s[0:1], 128
  v_lshrrev_b32 v3, 6, v0
  v_and_b32 v1, 63, v0
  v_and_b32 v2, 255, v0
  v_readfirstlane_b32 s70, v3
  s_and_b32 s65, s2, 7
  s_lshr_b32 s66, s2, 3
  s_and_b32 s64, s70, 3
  s_mul_i32 s71, s66, 37
  s_lshr_b32 s71, s71, 8
  s_mul_i32 s72, s71, 7
  s_sub_u32 s72, s66, s72
  s_lshr_b32 s67, s65, 1
  s_lshl_b32 s67, s67, 2
  s_add_u32 s67, s67, s71
  s_and_b32 s68, s65, 1
  s_mul_i32 s68, s68, 7
  s_add_u32 s68, s68, s72
  s_lshl_b32 s69, s71, 1
  s_add_u32 s69, s69, s72
  s_and_b32 s69, s69, 7
  s_cmp_lt_u32 s70, 4
  s_cbranch_scc1 L_main
  s_setprio 1
  v_lshrrev_b32 v152, 3, v1
  v_lshrrev_b32 v153, 1, v152
  v_and_b32 v154, 7, v1
  v_xor_b32 v154, v154, v153
  v_lshlrev_b32 v152, 10, v152
  v_lshl_add_u32 v144, v154, 4, v152
  v_xor_b32 v145, 64, v144
  v_add_u32 v146, 14336, v144
  v_add_u32 v145, 7168, v145
  v_add_u32 v147, 14336, v145
  v_lshrrev_b32 v152, 4, v1
  v_and_b32 v153, 15, v1
  v_lshlrev_b32 v154, 2, v152
  v_xor_b32 v153, v153, v154
  v_mul_u32_u24 v152, 3584, v152
  v_lshl_add_u32 v148, v153, 4, v152
  v_add_u32 v149, 13312, v148
  v_add_u32 v150, 26624, v148
  v_add_u32 v151, 39936, v148
  s_lshl_b32 s70, s67, 7
  s_lshl_b32 s71, s64, 5
  s_add_u32 s70, s70, s71
  s_lshl_b32 s90, s70, 10
  s_lshl_b32 s70, s68, 8
  s_mul_i32 s71, s64, 57344
  s_add_u32 s91, s70, s71
  s_cmp_ge_u32 s66, 28
  s_cselect_b32 s58, 0, 2097152
  s_cselect_b32 s46, 0, 1835008
  s_mov_b32 s59, 0x00020000
  s_mov_b32 s47, 0x00020000
  s_waitcnt lgkmcnt(0)
  s_mov_b32 s56, s4
  s_and_b32 s57, s5, 0xffff
  s_mov_b32 s44, s24
  s_and_b32 s45, s25, 0xffff
  s_add_u32 s80, s69, 0
  s_and_b32 s80, s80, 7
  s_lshl_b32 s82, s80, 7
  s_add_u32 s82, s82, s90
  s_mul_i32 s83, s80, 229376
  s_add_u32 s83, s83, s91
  s_lshl_b32 s84, s64, 12
  s_add_u32 s84, s84, 0
  s_mov_b32 m0, s84
  s_nop 0
  buffer_load_dwordx4 v144, s[56:59], s82 offen offset:0 lds
  buffer_load_dwordx4 v145, s[56:59], s82 offen offset:1024 lds
  buffer_load_dwordx4 v146, s[56:59], s82 offen offset:2048 lds
  buffer_load_dwordx4 v147, s[56:59], s82 offen offset:3072 lds
  s_add_u32 m0, s84, 16384
  s_nop 0
  buffer_load_dwordx4 v148, s[44:47], s83 offen offset:0 lds
  buffer_load_dwordx4 v149, s[44:47], s83 offen offset:1024 lds
  buffer_load_dwordx4 v150, s[44:47], s83 offen offset:2048 lds
  buffer_load_dwordx4 v151, s[44:47], s83 offen offset:3072 lds
  s_mov_b32 s52, s36
  s_and_b32 s53, s37, 0xffff
  s_mov_b32 s54, 268435456
  s_mov_b32 s55, 0x00020000
  s_mov_b32 s60, s34
  s_and_b32 s61, s35, 0xffff
  s_mov_b32 s62, 256
  s_mov_b32 s63, 0x00020000
  s_add_u32 s80, s69, 1
  s_and_b32 s80, s80, 7
  s_lshl_b32 s82, s80, 7
  s_add_u32 s82, s82, s90
  s_mul_i32 s83, s80, 229376
  s_add_u32 s83, s83, s91
  s_lshl_b32 s84, s64, 12
  s_add_u32 s84, s84, 32768
  s_mov_b32 m0, s84
  s_nop 0
  buffer_load_dwordx4 v144, s[56:59], s82 offen offset:0 lds
  buffer_load_dwordx4 v145, s[56:59], s82 offen offset:1024 lds
  buffer_load_dwordx4 v146, s[56:59], s82 offen offset:2048 lds
  buffer_load_dwordx4 v147, s[56:59], s82 offen offset:3072 lds
  s_add_u32 m0, s84, 16384
  s_nop 0
  buffer_load_dwordx4 v148, s[44:47], s83 offen offset:0 lds
  buffer_load_dwordx4 v149, s[44:47], s83 offen offset:1024 lds
  buffer_load_dwordx4 v150, s[44:47], s83 offen offset:2048 lds
  buffer_load_dwordx4 v151, s[44:47], s83 offen offset:3072 lds
  s_waitcnt vmcnt(8)
  s_barrier
  s_add_u32 s80, s69, 2
  s_and_b32 s80, s80, 7
  s_lshl_b32 s82, s80, 7
  s_add_u32 s82, s82, s90
  s_mul_i32 s83, s80, 229376
  s_add_u32 s83, s83, s91
  s_lshl_b32 s84, s64, 12
  s_add_u32 s84, s84, 65536
  s_mov_b32 m0, s84
  s_nop 0
  buffer_load_dwordx4 v144, s[56:59], s82 offen offset:0 lds
  buffer_load_dwordx4 v145, s[56:59], s82 offen offset:1024 lds
  buffer_load_dwordx4 v146, s[56:59], s82 offen offset:2048 lds
  buffer_load_dwordx4 v147, s[56:59], s82 offen offset:3072 lds
  s_add_u32 m0, s84, 16384
  s_nop 0
  buffer_load_dwordx4 v148, s[44:47], s83 offen offset:0 lds
  buffer_load_dwordx4 v149, s[44:47], s83 offen offset:1024 lds
  buffer_load_dwordx4 v150, s[44:47], s83 offen offset:2048 lds
  buffer_load_dwordx4 v151, s[44:47], s83 offen offset:3072 lds
  s_waitcnt vmcnt(8)
  s_barrier
  s_add_u32 s80, s69, 3
  s_and_b32 s80, s80, 7
  s_lshl_b32 s82, s80, 7
  s_add_u32 s82, s82, s90
  s_mul_i32 s83, s80, 229376
  s_add_u32 s83, s83, s91
  s_lshl_b32 s84, s64, 12
  s_add_u32 s84, s84, 98304
  s_mov_b32 m0, s84
  s_nop 0
  buffer_load_dwordx4 v144, s[56:59], s82 offen offset:0 lds
  buffer_load_dwordx4 v145, s[56:59], s82 offen offset:1024 lds
  buffer_load_dwordx4 v146, s[56:59], s82 offen offset:2048 lds
  buffer_load_dwordx4 v147, s[56:59], s82 offen offset:3072 lds
  s_add_u32 m0, s84, 16384
  s_nop 0
  buffer_load_dwordx4 v148, s[44:47], s83 offen offset:0 lds
  buffer_load_dwordx4 v149, s[44:47], s83 offen offset:1024 lds
  buffer_load_dwordx4 v150, s[44:47], s83 offen offset:2048 lds
  buffer_load_dwordx4 v151, s[44:47], s83 offen offset:3072 lds
  s_waitcnt vmcnt(8)
  s_barrier
  s_add_u32 s80, s69, 4
  s_and_b32 s80, s80, 7
  s_lshl_b32 s82, s80, 7
  s_add_u32 s82, s82, s90
  s_mul_i32 s83, s80, 229376
  s_add_u32 s83, s83, s91
  s_lshl_b32 s84, s64, 12
  s_add_u32 s84, s84, 0
  s_mov_b32 m0, s84
  s_nop 0
  buffer_load_dwordx4 v144, s[56:59], s82 offen offset:0 lds
  buffer_load_dwordx4 v145, s[56:59], s82 offen offset:1024 lds
  buffer_load_dwordx4 v146, s[56:59], s82 offen offset:2048 lds
  buffer_load_dwordx4 v147, s[56:59], s82 offen offset:3072 lds
  s_add_u32 m0, s84, 16384
  s_nop 0
  buffer_load_dwordx4 v148, s[44:47], s83 offen offset:0 lds
  buffer_load_dwordx4 v149, s[44:47], s83 offen offset:1024 lds
  buffer_load_dwordx4 v150, s[44:47], s83 offen offset:2048 lds
  buffer_load_dwordx4 v151, s[44:47], s83 offen offset:3072 lds
  s_add_u32 s80, s69, 5
  s_and_b32 s80, s80, 7
  s_lshl_b32 s82, s80, 7
  s_add_u32 s82, s82, s90
  s_mul_i32 s83, s80, 229376
  s_add_u32 s83, s83, s91
  s_lshl_b32 s84, s64, 12
  s_add_u32 s84, s84, 32768
  s_mov_b32 m0, s84
  s_nop 0
  buffer_load_dwordx4 v144, s[56:59], s82 offen offset:0 lds
  buffer_load_dwordx4 v145, s[56:59], s82 offen offset:1024 lds
  buffer_load_dwordx4 v146, s[56:59], s82 offen offset:2048 lds
  buffer_load_dwordx4 v147, s[56:59], s82 offen offset:3072 lds
  s_add_u32 m0, s84, 16384
  s_nop 0
  buffer_load_dwordx4 v148, s[44:47], s83 offen offset:0 lds
  buffer_load_dwordx4 v149, s[44:47], s83 offen offset:1024 lds
  buffer_load_dwordx4 v150, s[44:47], s83 offen offset:2048 lds
  buffer_load_dwordx4 v151, s[44:47], s83 offen offset:3072 lds
  s_waitcnt vmcnt(16)
  s_barrier
  s_add_u32 s80, s69, 6
  s_and_b32 s80, s80, 7
  s_lshl_b32 s82, s80, 7
  s_add_u32 s82, s82, s90
  s_mul_i32 s83, s80, 229376
  s_add_u32 s83, s83, s91
  s_lshl_b32 s84, s64, 12
  s_add_u32 s84, s84, 65536
  s_mov_b32 m0, s84
  s_nop 0
  buffer_load_dwordx4 v144, s[56:59], s82 offen offset:0 lds
  buffer_load_dwordx4 v145, s[56:59], s82 offen offset:1024 lds
  buffer_load_dwordx4 v146, s[56:59], s82 offen offset:2048 lds
  buffer_load_dwordx4 v147, s[56:59], s82 offen offset:3072 lds
  s_add_u32 m0, s84, 16384
  s_nop 0
  buffer_load_dwordx4 v148, s[44:47], s83 offen offset:0 lds
  buffer_load_dwordx4 v149, s[44:47], s83 offen offset:1024 lds
  buffer_load_dwordx4 v150, s[44:47], s83 offen offset:2048 lds
  buffer_load_dwordx4 v151, s[44:47], s83 offen offset:3072 lds
  v_and_b32 v137, 15, v1
  v_lshrrev_b32 v138, 4, v1
  v_lshlrev_b32 v139, 3, v138
  v_sub_u32 v139, v139, v137
  v_add_u32 v139, 2031, v139
  v_and_b32 v140, 1, v139
  v_mul_u32_u24 v140, 4158, v140
  v_lshl_add_u32 v139, v139, 1, v140
  s_lshr_b32 s70, s64, 1
  s_mul_i32 s71, s70, 8320
  s_and_b32 s72, s64, 1
  s_lshl_b32 s72, s72, 8
  s_add_u32 s72, s72, 192
  s_sub_u32 s71, s71, s72
  s_add_u32 s71, s71, 131072
  v_add_u32 v128, s71, v139
  v_subrev_u32 v129, 512, v128
  v_subrev_u32 v130, 1024, v128
  v_subrev_u32 v131, 1536, v128
  v_subrev_u32 v132, 2048, v128
  v_subrev_u32 v133, 2560, v128
  v_subrev_u32 v134, 3072, v128
  v_subrev_u32 v135, 3584, v128
  s_mul_i32 s71, s70, 4576
  s_sub_u32 s71, s71, s72
  s_add_u32 s71, s71, 148160
  v_lshlrev_b32 v137, 5, v137
  v_lshl_add_u32 v137, v138, 4, v137
  v_add_u32 v136, s71, v137
  s_waitcnt vmcnt(16)
  s_barrier
  s_add_u32 s80, s69, 7
  s_and_b32 s80, s80, 7
  s_lshl_b32 s82, s80, 7
  s_add_u32 s82, s82, s90
  s_mul_i32 s83, s80, 229376
  s_add_u32 s83, s83, s91
  s_lshl_b32 s84, s64, 12
  s_add_u32 s84, s84, 98304
  s_mov_b32 m0, s84
  s_nop 0
  buffer_load_dwordx4 v144, s[56:59], s82 offen offset:0 lds
  buffer_load_dwordx4 v145, s[56:59], s82 offen offset:1024 lds
  buffer_load_dwordx4 v146, s[56:59], s82 offen offset:2048 lds
  buffer_load_dwordx4 v147, s[56:59], s82 offen offset:3072 lds
  s_add_u32 m0, s84, 16384
  s_nop 0
  buffer_load_dwordx4 v148, s[44:47], s83 offen offset:0 lds
  buffer_load_dwordx4 v149, s[44:47], s83 offen offset:1024 lds
  buffer_load_dwordx4 v150, s[44:47], s83 offen offset:2048 lds
  buffer_load_dwordx4 v151, s[44:47], s83 offen offset:3072 lds
  v_lshlrev_b32 v21, 2, v2
  v_add_u32 v21, 141312, v21
  ds_read_u16 v8, v21 offset:0
  ds_read_u16 v9, v21 offset:2
  ds_read_u16 v10, v21 offset:1024
  ds_read_u16 v11, v21 offset:1026
  ds_read_u16 v12, v21 offset:2048
  ds_read_u16 v13, v21 offset:2050
  ds_read_u16 v14, v21 offset:3072
  ds_read_u16 v15, v21 offset:3074
  ds_read_b32 v20, v21 offset:4096
  v_lshlrev_b32 v21, 4, v2
  v_add_u32 v21, 146432, v21
  ds_read_b128 v[16:19], v21
  s_waitcnt vmcnt(16)
  s_barrier
  s_waitcnt lgkmcnt(3)
  v_lshlrev_b32 v14, 16, v14
  v_mul_f32 v48, 0x3fb8aa3b, v14
  s_mov_b32 s70, 0x3fb8aa3b
  v_fma_f32 v49, v14, s70, -v48
  v_fmac_f32 v49, 0x32a57060, v14
  v_exp_f32 v48, v48
  v_mul_f32 v49, 0x3f317218, v49
  v_fma_f32 v48, v48, v49, v48
  v_cvt_pk_bf16_f32 v48, v48, v48
  v_lshlrev_b32 v48, 16, v48
  v_lshlrev_b32 v8, 16, v8
  v_lshlrev_b32 v9, 16, v9
  v_lshlrev_b32 v10, 16, v10
  v_lshlrev_b32 v11, 16, v11
  v_lshlrev_b32 v12, 16, v12
  v_lshlrev_b32 v13, 16, v13
  s_waitcnt lgkmcnt(2)
  v_lshlrev_b32 v15, 16, v15
  v_mul_f32 v32, v48, v8
  v_mul_f32 v33, v48, v9
  v_mul_f32 v32, 0x3fb8aa3b, v32
  v_mul_f32 v33, 0x3e22f983, v33
  v_mul_f32 v10, v48, v10
  v_mul_f32 v11, v48, v11
  v_mul_f32 v54, v12, v10
  v_mul_f32 v55, v12, v11
  v_fma_f32 v54, -v13, v11, v54
  v_fma_f32 v55, v13, v10, v55
  v_mul_f32 v49, 0x43000000, v33
  v_mul_f32 v48, 0x43000000, v32
  v_fract_f32 v49, v49
  v_exp_f32 v48, v48
  v_cos_f32 v50, v49
  v_sin_f32 v51, v49
  v_mul_f32 v42, v48, v50
  v_mul_f32 v43, v48, v51
  v_mul_f32 v49, 0x41000000, v33
  v_mul_f32 v48, 0x41000000, v32
  v_fract_f32 v49, v49
  v_exp_f32 v48, v48
  v_cos_f32 v50, v49
  v_sin_f32 v51, v49
  v_mul_f32 v40, v48, v50
  v_mul_f32 v41, v48, v51
  v_fract_f32 v49, v33
  v_exp_f32 v48, v32
  v_cos_f32 v50, v49
  v_sin_f32 v51, v49
  v_mul_f32 v34, v48, v50
  v_mul_f32 v35, v48, v51
  v_pk_mul_f32 v[46:47], v[34:35], v[34:35] op_sel_hi:[0,1]
  v_pk_fma_f32 v[36:37], v[34:35], v[34:35], v[46:47] op_sel:[1,1,0] op_sel_hi:[1,0,1] neg_lo:[0,1,0]
  v_pk_mul_f32 v[46:47], v[36:37], v[36:37] op_sel_hi:[0,1]
  v_pk_fma_f32 v[38:39], v[36:37], v[36:37], v[46:47] op_sel:[1,1,0] op_sel_hi:[1,0,1] neg_lo:[0,1,0]
  s_lshr_b32 s70, s64, 1
  s_mul_i32 s70, s70, 30720
  s_add_u32 s70, s70, 98304
  s_and_b32 s71, s64, 1
  s_lshl_b32 s71, s71, 6
  v_add_u32 v53, s71, v1
  v_mul_u32_u24 v52, 112, v53
  v_add_u32 v52, s70, v52
  s_add_u32 s70, s70, 14336
  v_lshl_add_u32 v53, v53, 3, s70
  s_waitcnt vmcnt(8)
  s_barrier
  s_lshr_b32 s78, s2, 5
  s_lshl_b32 s78, s78, 7
  s_add_u32 s78, s78, 0
  v_and_b32 v156, 31, v1
  v_lshl_add_u32 v156, v156, 2, s78
  v_mov_b32 v157, 1
  s_cmp_lg_u32 s64, 0
  s_cbranch_scc1 L_g_1
  buffer_load_dword v155, v156, s[52:55], 0 offen sc1
L_g_1:
  s_waitcnt vmcnt(0)
  s_barrier
  s_setprio 3
  s_mov_b32 s48, s28
  s_and_b32 s49, s29, 0xffff
  s_mov_b32 s50, 1835008
  s_mov_b32 s51, 0x00020000
  s_lshl_b32 s70, s65, 2
  s_add_u32 s70, s70, s66
  s_and_b32 s70, s70, 31
  s_mul_i32 s70, s70, 56
  s_lshl_b32 s71, s64, 4
  s_add_u32 s70, s70, s71
  s_lshl_b32 s85, s70, 10
  v_lshlrev_b32 v148, 7, v1
  s_add_u32 s70, s85, 0
  buffer_load_dword v149, v148, s[48:51], s70 offen
  s_add_u32 s70, s85, 8192
  buffer_load_dword v150, v148, s[48:51], s70 offen
  v_mov_b32 v3, 163432
  s_waitcnt lgkmcnt(0)
  s_mov_b32 s88, 0
L_lw_2:
  ds_read_b32 v4, v3
  s_waitcnt lgkmcnt(0)
  v_readfirstlane_b32 s82, v4
  s_nop 0
  s_cmp_ge_u32 s82, 4
  s_cbranch_scc1 L_ld_3
  s_nop 0
  s_add_u32 s88, s88, 1
  s_cmp_gt_u32 s88, 0x100000
  s_cbranch_scc0 L_lw_2
L_ld_3:
  v_pk_mul_f32 v[74:75], v[54:55], v[42:43] op_sel_hi:[0,1]
  v_mov_b32 v112, 1.0
  v_pk_mul_f32 v[88:89], v[54:55], v[34:35] op_sel_hi:[0,1]
  v_pk_fma_f32 v[56:57], v[54:55], v[42:43], v[74:75] op_sel:[1,1,0] op_sel_hi:[1,0,1] neg_lo:[0,1,0]
  v_mov_b32 v113, 0
  v_pk_fma_f32 v[86:87], v[54:55], v[34:35], v[88:89] op_sel:[1,1,0] op_sel_hi:[1,0,1] neg_lo:[0,1,0]
  v_pk_mul_f32 v[102:103], v[56:57], v[34:35] op_sel_hi:[0,1]
  v_pk_mul_f32 v[74:75], v[56:57], v[42:43] op_sel_hi:[0,1]
  v_cvt_pk_bf16_f32 v118, v112, v40
  v_cvt_pk_bf16_f32 v90, v54, v86
  v_pk_fma_f32 v[100:101], v[56:57], v[34:35], v[102:103] op_sel:[1,1,0] op_sel_hi:[1,0,1] neg_lo:[0,1,0]
  v_pk_fma_f32 v[58:59], v[56:57], v[42:43], v[74:75] op_sel:[1,1,0] op_sel_hi:[1,0,1] neg_lo:[0,1,0]
  v_cvt_pk_bf16_f32 v122, -v113, -v41
  v_cvt_pk_bf16_f32 v94, v55, v87
  v_cvt_pk_bf16_f32 v104, v56, v100
  v_pk_mul_f32 v[74:75], v[58:59], v[42:43] op_sel_hi:[0,1]
  v_pk_mul_f32 v[116:117], v[40:41], v[40:41] op_sel_hi:[0,1]
  v_pk_mul_f32 v[88:89], v[86:87], v[34:35] op_sel_hi:[0,1]
  v_cvt_pk_bf16_f32 v108, v57, v101
  v_pk_fma_f32 v[60:61], v[58:59], v[42:43], v[74:75] op_sel:[1,1,0] op_sel_hi:[1,0,1] neg_lo:[0,1,0]
  v_pk_fma_f32 v[112:113], v[40:41], v[40:41], v[116:117] op_sel:[1,1,0] op_sel_hi:[1,0,1] neg_lo:[0,1,0]
  v_pk_fma_f32 v[84:85], v[86:87], v[34:35], v[88:89] op_sel:[1,1,0] op_sel_hi:[1,0,1] neg_lo:[0,1,0]
  v_pk_mul_f32 v[102:103], v[100:101], v[34:35] op_sel_hi:[0,1]
  v_pk_mul_f32 v[74:75], v[60:61], v[42:43] op_sel_hi:[0,1]
  v_pk_mul_f32 v[116:117], v[112:113], v[40:41] op_sel_hi:[0,1]
  v_pk_mul_f32 v[88:89], v[84:85], v[34:35] op_sel_hi:[0,1]
  v_pk_fma_f32 v[98:99], v[100:101], v[34:35], v[102:103] op_sel:[1,1,0] op_sel_hi:[1,0,1] neg_lo:[0,1,0]
  v_pk_fma_f32 v[62:63], v[60:61], v[42:43], v[74:75] op_sel:[1,1,0] op_sel_hi:[1,0,1] neg_lo:[0,1,0]
  v_pk_fma_f32 v[114:115], v[112:113], v[40:41], v[116:117] op_sel:[1,1,0] op_sel_hi:[1,0,1] neg_lo:[0,1,0]
  v_pk_fma_f32 v[86:87], v[84:85], v[34:35], v[88:89] op_sel:[1,1,0] op_sel_hi:[1,0,1] neg_lo:[0,1,0]
  v_pk_mul_f32 v[102:103], v[98:99], v[34:35] op_sel_hi:[0,1]
  v_pk_mul_f32 v[74:75], v[62:63], v[42:43] op_sel_hi:[0,1]
  v_cvt_pk_bf16_f32 v119, v112, v114
  v_cvt_pk_bf16_f32 v91, v84, v86
  v_pk_fma_f32 v[100:101], v[98:99], v[34:35], v[102:103] op_sel:[1,1,0] op_sel_hi:[1,0,1] neg_lo:[0,1,0]
  v_pk_fma_f32 v[64:65], v[62:63], v[42:43], v[74:75] op_sel:[1,1,0] op_sel_hi:[1,0,1] neg_lo:[0,1,0]
  v_cvt_pk_bf16_f32 v123, -v113, -v115
  v_cvt_pk_bf16_f32 v95, v85, v87
  v_cvt_pk_bf16_f32 v105, v98, v100
  v_pk_mul_f32 v[74:75], v[64:65], v[42:43] op_sel_hi:[0,1]
  v_pk_mul_f32 v[116:117], v[114:115], v[40:41] op_sel_hi:[0,1]
  v_pk_mul_f32 v[88:89], v[86:87], v[34:35] op_sel_hi:[0,1]
  v_cvt_pk_bf16_f32 v109, v99, v101
  v_pk_fma_f32 v[66:67], v[64:65], v[42:43], v[74:75] op_sel:[1,1,0] op_sel_hi:[1,0,1] neg_lo:[0,1,0]
  v_pk_fma_f32 v[112:113], v[114:115], v[40:41], v[116:117] op_sel:[1,1,0] op_sel_hi:[1,0,1] neg_lo:[0,1,0]
  v_pk_fma_f32 v[84:85], v[86:87], v[34:35], v[88:89] op_sel:[1,1,0] op_sel_hi:[1,0,1] neg_lo:[0,1,0]
  v_pk_mul_f32 v[102:103], v[100:101], v[34:35] op_sel_hi:[0,1]
  v_pk_mul_f32 v[74:75], v[66:67], v[42:43] op_sel_hi:[0,1]
  v_pk_mul_f32 v[116:117], v[112:113], v[40:41] op_sel_hi:[0,1]
  v_pk_mul_f32 v[88:89], v[84:85], v[34:35] op_sel_hi:[0,1]
  v_pk_fma_f32 v[98:99], v[100:101], v[34:35], v[102:103] op_sel:[1,1,0] op_sel_hi:[1,0,1] neg_lo:[0,1,0]
  v_pk_fma_f32 v[68:69], v[66:67], v[42:43], v[74:75] op_sel:[1,1,0] op_sel_hi:[1,0,1] neg_lo:[0,1,0]
  v_pk_fma_f32 v[114:115], v[112:113], v[40:41], v[116:117] op_sel:[1,1,0] op_sel_hi:[1,0,1] neg_lo:[0,1,0]
  v_pk_fma_f32 v[86:87], v[84:85], v[34:35], v[88:89] op_sel:[1,1,0] op_sel_hi:[1,0,1] neg_lo:[0,1,0]
  v_pk_mul_f32 v[102:103], v[98:99], v[34:35] op_sel_hi:[0,1]
  v_pk_mul_f32 v[74:75], v[68:69], v[42:43] op_sel_hi:[0,1]
  v_cvt_pk_bf16_f32 v120, v112, v114
  v_cvt_pk_bf16_f32 v92, v84, v86
  v_pk_fma_f32 v[100:101], v[98:99], v[34:35], v[102:103] op_sel:[1,1,0] op_sel_hi:[1,0,1] neg_lo:[0,1,0]
  v_pk_fma_f32 v[70:71], v[68:69], v[42:43], v[74:75] op_sel:[1,1,0] op_sel_hi:[1,0,1] neg_lo:[0,1,0]
  v_cvt_pk_bf16_f32 v124, -v113, -v115
  v_cvt_pk_bf16_f32 v96, v85, v87
  v_cvt_pk_bf16_f32 v106, v98, v100
  v_pk_mul_f32 v[74:75], v[70:71], v[42:43] op_sel_hi:[0,1]
  v_pk_mul_f32 v[116:117], v[114:115], v[40:41] op_sel_hi:[0,1]
  v_pk_mul_f32 v[88:89], v[86:87], v[34:35] op_sel_hi:[0,1]
  v_cvt_pk_bf16_f32 v110, v99, v101
  v_pk_fma_f32 v[72:73], v[70:71], v[42:43], v[74:75] op_sel:[1,1,0] op_sel_hi:[1,0,1] neg_lo:[0,1,0]
  v_pk_fma_f32 v[112:113], v[114:115], v[40:41], v[116:117] op_sel:[1,1,0] op_sel_hi:[1,0,1] neg_lo:[0,1,0]
  v_pk_fma_f32 v[84:85], v[86:87], v[34:35], v[88:89] op_sel:[1,1,0] op_sel_hi:[1,0,1] neg_lo:[0,1,0]
  v_pk_mul_f32 v[102:103], v[100:101], v[34:35] op_sel_hi:[0,1]
  v_cvt_pk_bf16_f32 v76, v70, v72
  v_pk_mul_f32 v[116:117], v[112:113], v[40:41] op_sel_hi:[0,1]
  v_pk_mul_f32 v[88:89], v[84:85], v[34:35] op_sel_hi:[0,1]
  v_pk_fma_f32 v[98:99], v[100:101], v[34:35], v[102:103] op_sel:[1,1,0] op_sel_hi:[1,0,1] neg_lo:[0,1,0]
  v_cvt_pk_bf16_f32 v80, v71, v73
  v_pk_fma_f32 v[114:115], v[112:113], v[40:41], v[116:117] op_sel:[1,1,0] op_sel_hi:[1,0,1] neg_lo:[0,1,0]
  v_pk_fma_f32 v[86:87], v[84:85], v[34:35], v[88:89] op_sel:[1,1,0] op_sel_hi:[1,0,1] neg_lo:[0,1,0]
  v_pk_mul_f32 v[102:103], v[98:99], v[34:35] op_sel_hi:[0,1]
  v_pk_mul_f32 v[74:75], v[72:73], v[42:43] op_sel_hi:[0,1]
  v_cvt_pk_bf16_f32 v121, v112, v114
  v_cvt_pk_bf16_f32 v93, v84, v86
  v_pk_fma_f32 v[100:101], v[98:99], v[34:35], v[102:103] op_sel:[1,1,0] op_sel_hi:[1,0,1] neg_lo:[0,1,0]
  v_pk_fma_f32 v[70:71], v[72:73], v[42:43], v[74:75] op_sel:[1,1,0] op_sel_hi:[1,0,1] neg_lo:[0,1,0]
  v_cvt_pk_bf16_f32 v125, -v113, -v115
  v_cvt_pk_bf16_f32 v97, v85, v87
  v_cvt_pk_bf16_f32 v107, v98, v100
  v_pk_mul_f32 v[74:75], v[70:71], v[42:43] op_sel_hi:[0,1]
  ds_write_b128 v52, v[118:121] offset:80
  ds_write_b128 v52, v[90:93] offset:0
  v_cvt_pk_bf16_f32 v111, v99, v101
  v_pk_fma_f32 v[72:73], v[70:71], v[42:43], v[74:75] op_sel:[1,1,0] op_sel_hi:[1,0,1] neg_lo:[0,1,0]
  ds_write_b128 v52, v[122:125] offset:15440
  ds_write_b128 v52, v[94:97] offset:15360
  ds_write_b128 v52, v[104:107] offset:16
  v_cvt_pk_bf16_f32 v77, v70, v72
  v_pk_mul_f32 v[116:117], v[114:115], v[40:41] op_sel_hi:[0,1]
  v_pk_mul_f32 v[88:89], v[58:59], v[36:37] op_sel_hi:[0,1]
  ds_write_b128 v52, v[108:111] offset:15376
  v_cvt_pk_bf16_f32 v81, v71, v73
  v_pk_fma_f32 v[112:113], v[114:115], v[40:41], v[116:117] op_sel:[1,1,0] op_sel_hi:[1,0,1] neg_lo:[0,1,0]
  v_pk_fma_f32 v[86:87], v[58:59], v[36:37], v[88:89] op_sel:[1,1,0] op_sel_hi:[1,0,1] neg_lo:[0,1,0]
  v_pk_mul_f32 v[102:103], v[62:63], v[38:39] op_sel_hi:[0,1]
  v_pk_mul_f32 v[74:75], v[72:73], v[42:43] op_sel_hi:[0,1]
  v_pk_mul_f32 v[116:117], v[112:113], v[40:41] op_sel_hi:[0,1]
  v_cvt_pk_bf16_f32 v90, v58, v86
  v_pk_fma_f32 v[100:101], v[62:63], v[38:39], v[102:103] op_sel:[1,1,0] op_sel_hi:[1,0,1] neg_lo:[0,1,0]
  v_pk_fma_f32 v[70:71], v[72:73], v[42:43], v[74:75] op_sel:[1,1,0] op_sel_hi:[1,0,1] neg_lo:[0,1,0]
  v_pk_fma_f32 v[114:115], v[112:113], v[40:41], v[116:117] op_sel:[1,1,0] op_sel_hi:[1,0,1] neg_lo:[0,1,0]
  v_cvt_pk_bf16_f32 v94, v59, v87
  v_cvt_pk_bf16_f32 v104, v62, v100
  v_pk_mul_f32 v[74:75], v[70:71], v[42:43] op_sel_hi:[0,1]
  v_cvt_pk_bf16_f32 v118, v112, v114
  v_pk_mul_f32 v[88:89], v[86:87], v[36:37] op_sel_hi:[0,1]
  v_cvt_pk_bf16_f32 v108, v63, v101
  v_pk_fma_f32 v[72:73], v[70:71], v[42:43], v[74:75] op_sel:[1,1,0] op_sel_hi:[1,0,1] neg_lo:[0,1,0]
  v_cvt_pk_bf16_f32 v122, -v113, -v115
  v_pk_fma_f32 v[84:85], v[86:87], v[36:37], v[88:89] op_sel:[1,1,0] op_sel_hi:[1,0,1] neg_lo:[0,1,0]
  v_pk_mul_f32 v[102:103], v[64:65], v[38:39] op_sel_hi:[0,1]
  v_cvt_pk_bf16_f32 v78, v70, v72
  v_pk_mul_f32 v[116:117], v[114:115], v[40:41] op_sel_hi:[0,1]
  v_pk_mul_f32 v[88:89], v[84:85], v[36:37] op_sel_hi:[0,1]
  v_pk_fma_f32 v[100:101], v[64:65], v[38:39], v[102:103] op_sel:[1,1,0] op_sel_hi:[1,0,1] neg_lo:[0,1,0]
  v_cvt_pk_bf16_f32 v82, v71, v73
  v_pk_fma_f32 v[112:113], v[114:115], v[40:41], v[116:117] op_sel:[1,1,0] op_sel_hi:[1,0,1] neg_lo:[0,1,0]
  v_pk_fma_f32 v[86:87], v[84:85], v[36:37], v[88:89] op_sel:[1,1,0] op_sel_hi:[1,0,1] neg_lo:[0,1,0]
  v_cvt_pk_bf16_f32 v105, v64, v100
  v_pk_mul_f32 v[74:75], v[72:73], v[42:43] op_sel_hi:[0,1]
  v_pk_mul_f32 v[116:117], v[112:113], v[40:41] op_sel_hi:[0,1]
  v_cvt_pk_bf16_f32 v91, v84, v86
  v_cvt_pk_bf16_f32 v109, v65, v101
  v_pk_fma_f32 v[70:71], v[72:73], v[42:43], v[74:75] op_sel:[1,1,0] op_sel_hi:[1,0,1] neg_lo:[0,1,0]
  v_pk_fma_f32 v[114:115], v[112:113], v[40:41], v[116:117] op_sel:[1,1,0] op_sel_hi:[1,0,1] neg_lo:[0,1,0]
  v_cvt_pk_bf16_f32 v95, v85, v87
  v_pk_mul_f32 v[102:103], v[66:67], v[38:39] op_sel_hi:[0,1]
  v_pk_mul_f32 v[74:75], v[70:71], v[42:43] op_sel_hi:[0,1]
  v_cvt_pk_bf16_f32 v119, v112, v114
  v_pk_mul_f32 v[88:89], v[60:61], v[36:37] op_sel_hi:[0,1]
  v_pk_fma_f32 v[100:101], v[66:67], v[38:39], v[102:103] op_sel:[1,1,0] op_sel_hi:[1,0,1] neg_lo:[0,1,0]
  v_pk_fma_f32 v[72:73], v[70:71], v[42:43], v[74:75] op_sel:[1,1,0] op_sel_hi:[1,0,1] neg_lo:[0,1,0]
  v_cvt_pk_bf16_f32 v123, -v113, -v115
  v_pk_fma_f32 v[86:87], v[60:61], v[36:37], v[88:89] op_sel:[1,1,0] op_sel_hi:[1,0,1] neg_lo:[0,1,0]
  v_cvt_pk_bf16_f32 v106, v66, v100
  v_cvt_pk_bf16_f32 v79, v70, v72
  v_pk_mul_f32 v[116:117], v[114:115], v[40:41] op_sel_hi:[0,1]
  v_cvt_pk_bf16_f32 v92, v60, v86
  v_cvt_pk_bf16_f32 v110, v67, v101
  v_cvt_pk_bf16_f32 v83, v71, v73
  v_pk_fma_f32 v[112:113], v[114:115], v[40:41], v[116:117] op_sel:[1,1,0] op_sel_hi:[1,0,1] neg_lo:[0,1,0]
  v_cvt_pk_bf16_f32 v96, v61, v87
  v_pk_mul_f32 v[102:103], v[68:69], v[38:39] op_sel_hi:[0,1]
  v_pk_mul_f32 v[74:75], v[72:73], v[42:43] op_sel_hi:[0,1]
  v_pk_mul_f32 v[116:117], v[112:113], v[40:41] op_sel_hi:[0,1]
  v_pk_mul_f32 v[88:89], v[86:87], v[36:37] op_sel_hi:[0,1]
  v_pk_fma_f32 v[100:101], v[68:69], v[38:39], v[102:103] op_sel:[1,1,0] op_sel_hi:[1,0,1] neg_lo:[0,1,0]
  v_pk_fma_f32 v[70:71], v[72:73], v[42:43], v[74:75] op_sel:[1,1,0] op_sel_hi:[1,0,1] neg_lo:[0,1,0]
  v_pk_fma_f32 v[114:115], v[112:113], v[40:41], v[116:117] op_sel:[1,1,0] op_sel_hi:[1,0,1] neg_lo:[0,1,0]
  v_pk_fma_f32 v[84:85], v[86:87], v[36:37], v[88:89] op_sel:[1,1,0] op_sel_hi:[1,0,1] neg_lo:[0,1,0]
  v_cvt_pk_bf16_f32 v107, v68, v100
  ds_write_b128 v52, v[76:79] offset:64
  v_cvt_pk_bf16_f32 v120, v112, v114
  v_pk_mul_f32 v[88:89], v[84:85], v[36:37] op_sel_hi:[0,1]
  v_cvt_pk_bf16_f32 v111, v69, v101
  ds_write_b128 v52, v[80:83] offset:15424
  v_cvt_pk_bf16_f32 v124, -v113, -v115
  v_pk_fma_f32 v[86:87], v[84:85], v[36:37], v[88:89] op_sel:[1,1,0] op_sel_hi:[1,0,1] neg_lo:[0,1,0]
  ds_write_b128 v52, v[104:107] offset:48
  v_cvt_pk_bf16_f32 v76, v70, 0
  v_pk_mul_f32 v[116:117], v[114:115], v[40:41] op_sel_hi:[0,1]
  v_cvt_pk_bf16_f32 v93, v84, v86
  ds_write_b128 v52, v[108:111] offset:15408
  v_cvt_pk_bf16_f32 v80, v71, 0
  v_pk_fma_f32 v[112:113], v[114:115], v[40:41], v[116:117] op_sel:[1,1,0] op_sel_hi:[1,0,1] neg_lo:[0,1,0]
  v_cvt_pk_bf16_f32 v97, v85, v87
  v_mov_b32 v77, 0
  v_pk_mul_f32 v[116:117], v[112:113], v[40:41] op_sel_hi:[0,1]
  ds_write_b128 v52, v[90:93] offset:32
  v_mov_b32 v81, 0
  v_pk_fma_f32 v[114:115], v[112:113], v[40:41], v[116:117] op_sel:[1,1,0] op_sel_hi:[1,0,1] neg_lo:[0,1,0]
  ds_write_b128 v52, v[94:97] offset:15392
  ds_write_b64 v53, v[76:77]
  v_cvt_pk_bf16_f32 v121, v112, v114
  ds_write_b64 v53, v[80:81] offset:15360
  v_cvt_pk_bf16_f32 v125, -v113, -v115
  ds_write_b128 v52, v[118:121] offset:96
  ds_write_b128 v52, v[122:125] offset:15456
  v_mov_b32 v3, 163488
  s_cmp_lg_u32 s64, 0
  s_cbranch_scc1 L_po_4
  s_waitcnt vmcnt(2)
  v_cmp_lt_u32 vcc, v155, v157
  s_cbranch_vccz L_pd_6
  s_mov_b32 s88, 0
  buffer_load_dword v155, v156, s[52:55], 0 offen sc1
L_pl_7:
  s_sleep 3
  buffer_load_dword v5, v156, s[52:55], 0 offen sc1
  s_waitcnt vmcnt(1)
  v_cmp_lt_u32 vcc, v155, v157
  s_cbranch_vccz L_pr_8
  s_sleep 3
  buffer_load_dword v155, v156, s[52:55], 0 offen sc1
  s_waitcnt vmcnt(1)
  s_add_u32 s88, s88, 1
  s_cmp_gt_u32 s88, 0x10000
  s_cbranch_scc1 L_pr_8
  v_cmp_lt_u32 vcc, v5, v157
  s_cbranch_vccnz L_pl_7
L_pr_8:
  s_waitcnt vmcnt(0)
L_pd_6:
  v_mov_b32 v4, 1
  ds_write_b32 v3, v4
  s_branch L_pj_5
L_po_4:
  s_waitcnt lgkmcnt(0)
  s_mov_b32 s88, 0
L_lw_9:
  ds_read_b32 v4, v3
  s_waitcnt lgkmcnt(0)
  v_readfirstlane_b32 s82, v4
  s_nop 0
  s_cmp_ge_u32 s82, 1
  s_cbranch_scc1 L_ld_10
  s_nop 0
  s_add_u32 s88, s88, 1
  s_cmp_gt_u32 s88, 0x100000
  s_cbranch_scc0 L_lw_9
L_ld_10:
L_pj_5:
  s_waitcnt lgkmcnt(0)
  s_lshl_b32 s70, s2, 1
  s_lshr_b32 s71, s64, 1
  s_add_u32 s70, s70, s71
  s_lshl_b32 s70, s70, 12
  s_and_b32 s71, s64, 1
  s_lshl_b32 s71, s71, 11
  s_add_u32 s70, s70, s71
  s_add_u32 s70, s70, 1048576
  v_lshlrev_b32 v126, 4, v1
  buffer_load_dwordx4 a[0:3], v126, s[52:55], s70 offen sc1
  buffer_load_dwordx4 a[4:7], v126, s[52:55], s70 offen offset:1024 sc1
  s_lshr_b32 s70, s64, 1
  s_mul_i32 s70, s70, 4576
  s_and_b32 s71, s64, 1
  s_lshl_b32 s71, s71, 11
  s_add_u32 s70, s70, s71
  s_add_u32 s70, s70, 148192
  v_lshl_add_u32 v126, v1, 4, s70
  v_mov_b32 v3, 163448
  v_mov_b32 v4, 1
  s_waitcnt lgkmcnt(0)
  s_mov_b64 exec, 1
  ds_add_u32 v3, v4
  s_mov_b64 exec, -1
  s_waitcnt lgkmcnt(0)
  s_mov_b32 s88, 0
L_lw_11:
  ds_read_b32 v5, v3
  s_waitcnt lgkmcnt(0)
  v_readfirstlane_b32 s82, v5
  s_nop 0
  s_cmp_ge_u32 s82, 4
  s_cbranch_scc1 L_ld_12
  s_nop 0
  s_add_u32 s88, s88, 1
  s_cmp_gt_u32 s88, 0x100000
  s_cbranch_scc0 L_lw_11
L_ld_12:
  v_lshrrev_b32 v43, 4, v1
  v_bfe_u32 v42, v1, 2, 2
  v_lshl_add_u32 v43, v43, 3, v42
  v_and_b32 v42, 3, v1
  s_lshr_b32 s70, s64, 1
  s_mul_i32 s70, s70, 30720
  s_add_u32 s70, s70, 98304
  v_mul_u32_u24 v41, 112, v43
  v_lshl_add_u32 v41, v42, 3, v41
  v_add_u32 v41, s70, v41
  v_add_u32 v40, 32, v41
  s_and_b32 s71, s64, 1
  s_lshl_b32 s72, s71, 6
  v_add_u32 v32, s72, v41
  v_lshlrev_b32 v43, 3, v43
  s_add_u32 s70, s70, 14336
  v_add_u32 v43, s70, v43
  v_lshrrev_b32 v42, 1, v42
  v_and_b32 v42, s71, v42
  v_cmp_eq_u32 vcc, 1, v42
  s_nop 1
  v_cndmask_b32 v32, v32, v43, vcc
  v_mov_b32 v42, 112
  v_cndmask_b32 v42, v42, 8, vcc
  v_mad_u32_u24 v33, v42, 4, v32
  v_mad_u32_u24 v34, v42, 32, v32
  v_mad_u32_u24 v35, v42, 36, v32
  v_mad_u32_u24 v36, v42, 64, v32
  v_mov_b32 v43, 68
  v_mad_u32_u24 v37, v42, v43, v32
  v_mov_b32 v43, 96
  v_mad_u32_u24 v38, v42, v43, v32
  v_mov_b32 v43, 100
  v_mad_u32_u24 v39, v42, v43, v32
  v_add_u32 v41, 80, v41
  ds_read_b64_tr_b16 v[52:53], v32 offset:0
  ds_read_b64_tr_b16 v[56:57], v40 offset:0
  ds_read_b64_tr_b16 v[60:61], v41 offset:0
  ds_read_b64_tr_b16 v[54:55], v33 offset:0
  ds_read_b64_tr_b16 v[58:59], v40 offset:448
  ds_read_b64_tr_b16 v[62:63], v41 offset:448
  ds_read_b64_tr_b16 v[64:65], v34 offset:0
  ds_read_b64_tr_b16 v[68:69], v40 offset:3584
  ds_read_b64_tr_b16 v[72:73], v41 offset:3584
  ds_read_b64_tr_b16 v[66:67], v35 offset:0
  ds_read_b64_tr_b16 v[70:71], v40 offset:4032
  ds_read_b64_tr_b16 v[74:75], v41 offset:4032
  ds_read_b64_tr_b16 v[76:77], v36 offset:0
  ds_read_b64_tr_b16 v[80:81], v40 offset:7168
  ds_read_b64_tr_b16 v[84:85], v41 offset:7168
  ds_read_b64_tr_b16 v[78:79], v37 offset:0
  ds_read_b64_tr_b16 v[82:83], v40 offset:7616
  ds_read_b64_tr_b16 v[86:87], v41 offset:7616
  s_waitcnt lgkmcnt(12)
  v_mfma_f32_16x16x32_bf16 v[44:47], v[52:55], v[60:63], 0
  v_mfma_f32_16x16x32_bf16 v[48:51], v[56:59], v[60:63], 0
  ds_read_b64_tr_b16 v[88:89], v38 offset:0
  ds_read_b64_tr_b16 v[92:93], v40 offset:10752
  ds_read_b64_tr_b16 v[96:97], v41 offset:10752
  ds_read_b64_tr_b16 v[90:91], v39 offset:0
  ds_read_b64_tr_b16 v[94:95], v40 offset:11200
  ds_read_b64_tr_b16 v[98:99], v41 offset:11200
  s_waitcnt lgkmcnt(12)
  v_mfma_f32_16x16x32_bf16 v[44:47], v[64:67], v[72:75], v[44:47]
  v_mfma_f32_16x16x32_bf16 v[48:51], v[68:71], v[72:75], v[48:51]
  ds_read_b64_tr_b16 v[52:53], v32 offset:15360
  ds_read_b64_tr_b16 v[56:57], v40 offset:15360
  ds_read_b64_tr_b16 v[60:61], v41 offset:15360
  ds_read_b64_tr_b16 v[54:55], v33 offset:15360
  ds_read_b64_tr_b16 v[58:59], v40 offset:15808
  ds_read_b64_tr_b16 v[62:63], v41 offset:15808
  s_waitcnt lgkmcnt(12)
  v_mfma_f32_16x16x32_bf16 v[44:47], v[76:79], v[84:87], v[44:47]
  v_mfma_f32_16x16x32_bf16 v[48:51], v[80:83], v[84:87], v[48:51]
  ds_read_b64_tr_b16 v[64:65], v34 offset:15360
  ds_read_b64_tr_b16 v[68:69], v40 offset:18944
  ds_read_b64_tr_b16 v[72:73], v41 offset:18944
  ds_read_b64_tr_b16 v[66:67], v35 offset:15360
  ds_read_b64_tr_b16 v[70:71], v40 offset:19392
  ds_read_b64_tr_b16 v[74:75], v41 offset:19392
  s_waitcnt lgkmcnt(12)
  v_mfma_f32_16x16x32_bf16 v[44:47], v[88:91], v[96:99], v[44:47]
  v_mfma_f32_16x16x32_bf16 v[48:51], v[92:95], v[96:99], v[48:51]
  ds_read_b64_tr_b16 v[76:77], v36 offset:15360
  ds_read_b64_tr_b16 v[80:81], v40 offset:22528
  ds_read_b64_tr_b16 v[84:85], v41 offset:22528
  ds_read_b64_tr_b16 v[78:79], v37 offset:15360
  ds_read_b64_tr_b16 v[82:83], v40 offset:22976
  ds_read_b64_tr_b16 v[86:87], v41 offset:22976
  s_waitcnt lgkmcnt(12)
  v_mfma_f32_16x16x32_bf16 v[44:47], v[52:55], v[60:63], v[44:47]
  v_mfma_f32_16x16x32_bf16 v[48:51], v[56:59], v[60:63], v[48:51]
  ds_read_b64_tr_b16 v[88:89], v38 offset:15360
  ds_read_b64_tr_b16 v[92:93], v40 offset:26112
  ds_read_b64_tr_b16 v[96:97], v41 offset:26112
  ds_read_b64_tr_b16 v[90:91], v39 offset:15360
  ds_read_b64_tr_b16 v[94:95], v40 offset:26560
  ds_read_b64_tr_b16 v[98:99], v41 offset:26560
  s_waitcnt lgkmcnt(12)
  v_mfma_f32_16x16x32_bf16 v[44:47], v[64:67], v[72:75], v[44:47]
  v_mfma_f32_16x16x32_bf16 v[48:51], v[68:71], v[72:75], v[48:51]
  s_waitcnt lgkmcnt(6)
  v_mfma_f32_16x16x32_bf16 v[44:47], v[76:79], v[84:87], v[44:47]
  v_mfma_f32_16x16x32_bf16 v[48:51], v[80:83], v[84:87], v[48:51]
  s_waitcnt lgkmcnt(0)
  v_mfma_f32_16x16x32_bf16 v[44:47], v[88:91], v[96:99], v[44:47]
  v_mfma_f32_16x16x32_bf16 v[48:51], v[92:95], v[96:99], v[48:51]
  s_and_b32 s71, s64, 1
  v_or_b32 v52, s71, v1
  v_cmp_eq_u32 vcc, 0, v52
  s_nop 1
  v_cndmask_b32 v52, 0, v15, vcc
  s_lshr_b32 s70, s64, 1
  s_mul_i32 s70, s70, 1552
  s_add_u32 s70, s70, 160320
  v_lshl_add_u32 v53, v1, 3, s70
  s_lshl_b32 s71, s71, 10
  v_add_u32 v54, s71, v53
  v_mov_b32 v60, 0
  v_mov_b32 v55, s70
  v_add_f32 v44, v44, v52
  v_cvt_pk_bf16_f32 v56, v44, v45
  v_cvt_pk_bf16_f32 v57, v46, v47
  v_cvt_pk_bf16_f32 v58, v48, v49
  v_cvt_pk_bf16_f32 v59, v50, v51
  ds_write_b64 v54, v[56:57]
  ds_write_b64 v53, v[58:59] offset:512
  ds_write_b32 v55, v60 offset:1536
  v_mov_b32 v3, 163452
  v_mov_b32 v4, 1
  s_waitcnt lgkmcnt(0)
  s_mov_b64 exec, 1
  ds_add_u32 v3, v4
  s_mov_b64 exec, -1
  s_waitcnt lgkmcnt(0)
  s_mov_b32 s88, 0
L_lw_13:
  ds_read_b32 v5, v3
  s_waitcnt lgkmcnt(0)
  v_readfirstlane_b32 s82, v5
  s_nop 0
  s_cmp_ge_u32 s82, 4
  s_cbranch_scc1 L_ld_14
  s_nop 0
  s_add_u32 s88, s88, 1
  s_cmp_gt_u32 s88, 0x100000
  s_cbranch_scc0 L_lw_13
L_ld_14:
  v_mov_b32 v41, 160320
  v_add_u32_sdwa v32, v41, v16 dst_sel:DWORD dst_unused:UNUSED_PAD src0_sel:DWORD src1_sel:WORD_0
  v_add_u32_sdwa v33, v41, v16 dst_sel:DWORD dst_unused:UNUSED_PAD src0_sel:DWORD src1_sel:WORD_1
  v_add_u32_sdwa v34, v41, v17 dst_sel:DWORD dst_unused:UNUSED_PAD src0_sel:DWORD src1_sel:WORD_0
  v_add_u32_sdwa v35, v41, v17 dst_sel:DWORD dst_unused:UNUSED_PAD src0_sel:DWORD src1_sel:WORD_1
  v_add_u32_sdwa v36, v41, v18 dst_sel:DWORD dst_unused:UNUSED_PAD src0_sel:DWORD src1_sel:WORD_0
  v_add_u32_sdwa v37, v41, v18 dst_sel:DWORD dst_unused:UNUSED_PAD src0_sel:DWORD src1_sel:WORD_1
  v_add_u32_sdwa v38, v41, v19 dst_sel:DWORD dst_unused:UNUSED_PAD src0_sel:DWORD src1_sel:WORD_0
  v_add_u32_sdwa v39, v41, v19 dst_sel:DWORD dst_unused:UNUSED_PAD src0_sel:DWORD src1_sel:WORD_1
  v_add_u32 v40, v41, v20
  v_lshlrev_b32 v82, 4, v2
  ds_read_u16 v42, v32 offset:0
  ds_read_u16 v43, v33 offset:0
  ds_read_u16 v44, v34 offset:0
  ds_read_u16 v45, v35 offset:0
  ds_read_u16 v46, v36 offset:0
  ds_read_u16 v47, v37 offset:0
  ds_read_u16 v48, v38 offset:0
  ds_read_u16 v49, v39 offset:0
  ds_read_u16 v50, v40 offset:0
  ds_read_u16 v60, v32 offset:1552
  ds_read_u16 v61, v33 offset:1552
  ds_read_u16 v62, v34 offset:1552
  ds_read_u16 v63, v35 offset:1552
  ds_read_u16 v64, v36 offset:1552
  ds_read_u16 v65, v37 offset:1552
  ds_read_u16 v66, v38 offset:1552
  ds_read_u16 v67, v39 offset:1552
  ds_read_u16 v68, v40 offset:1552
  v_add_u32 v82, 131072, v82
  s_waitcnt lgkmcnt(15)
  v_lshl_or_b32 v52, v43, 16, v42
  s_waitcnt lgkmcnt(14)
  v_lshl_or_b32 v53, v45, 16, v44
  s_waitcnt lgkmcnt(12)
  v_lshl_or_b32 v54, v47, 16, v46
  s_waitcnt lgkmcnt(10)
  v_lshl_or_b32 v55, v49, 16, v48
  v_lshl_or_b32 v56, v44, 16, v43
  v_lshl_or_b32 v57, v46, 16, v45
  v_lshl_or_b32 v58, v48, 16, v47
  s_waitcnt lgkmcnt(9)
  v_lshl_or_b32 v59, v50, 16, v49
  ds_write_b128 v82, v[52:55] offset:0
  ds_write_b128 v82, v[56:59] offset:4160
  s_waitcnt lgkmcnt(9)
  v_lshl_or_b32 v70, v61, 16, v60
  s_waitcnt lgkmcnt(7)
  v_lshl_or_b32 v71, v63, 16, v62
  s_waitcnt lgkmcnt(5)
  v_lshl_or_b32 v72, v65, 16, v64
  s_waitcnt lgkmcnt(3)
  v_lshl_or_b32 v73, v67, 16, v66
  v_lshl_or_b32 v74, v62, 16, v61
  v_lshl_or_b32 v75, v64, 16, v63
  v_lshl_or_b32 v76, v66, 16, v65
  s_waitcnt lgkmcnt(2)
  v_lshl_or_b32 v77, v68, 16, v67
  ds_write_b128 v82, v[70:73] offset:8320
  ds_write_b128 v82, v[74:77] offset:12480
  v_mov_b32 v78, 0
  v_mov_b32 v79, 0
  v_mov_b32 v80, 0
  v_mov_b32 v81, 0
  v_lshrrev_b32 v32, 2, v2
  v_mul_u32_u24 v32, 4160, v32
  v_and_b32 v33, 3, v2
  v_lshl_add_u32 v32, v33, 4, v32
  v_add_u32 v32, 135168, v32
  v_subrev_u32 v33, 16, v2
  v_cmp_le_u32 vcc, 30, v33
  s_nop 1
  v_cndmask_b32 v34, 0, 1, vcc
  v_mul_u32_u24 v34, 4096, v34
  v_lshl_add_u32 v33, v33, 4, v34
  v_add_u32 v33, 147712, v33
  v_cmp_gt_u32 vcc, 16, v2
  s_nop 1
  v_cndmask_b32 v32, v33, v32, vcc
  v_cmp_gt_u32 vcc, 76, v2
  s_nop 0
  s_and_saveexec_b64 s[70:71], vcc
  ds_write_b128 v32, v[78:81]
  s_mov_b64 exec, s[70:71]
  s_waitcnt vmcnt(1)
  ds_write_b128 v126, a[0:3]
  s_waitcnt vmcnt(0)
  ds_write_b128 v126, a[4:7] offset:1024
  v_mov_b32 v3, 163460
  v_mov_b32 v4, 1
  s_waitcnt lgkmcnt(0)
  s_mov_b64 exec, 1
  ds_add_u32 v3, v4
  s_mov_b64 exec, -1
  s_waitcnt lgkmcnt(0)
  s_mov_b32 s88, 0
L_lw_15:
  ds_read_b32 v5, v3
  s_waitcnt lgkmcnt(0)
  v_readfirstlane_b32 s82, v5
  s_nop 0
  s_cmp_ge_u32 s82, 4
  s_cbranch_scc1 L_ld_16
  s_nop 0
  s_add_u32 s88, s88, 1
  s_cmp_gt_u32 s88, 0x100000
  s_cbranch_scc0 L_lw_15
L_ld_16:
  ds_read2_b32 v[64:65], v128 offset0:48 offset1:49
  ds_read2_b32 v[66:67], v128 offset0:50 offset1:51
  ds_read_b128 v[124:127], v136 offset:3776
  ds_read_b128 v[120:123], v136 offset:3264
  ds_read_b128 v[116:119], v136 offset:2752
  ds_read_b128 v[112:115], v136 offset:2240
  ds_read_b128 v[108:111], v136 offset:1728
  ds_read_b128 v[104:107], v136 offset:1216
  ds_read_b128 v[100:103], v136 offset:704
  ds_read_b128 v[96:99], v136 offset:192
  ds_read2_b32 v[68:69], v129 offset0:48 offset1:49
  ds_read2_b32 v[70:71], v129 offset0:50 offset1:51
  ds_read2_b32 v[72:73], v130 offset0:48 offset1:49
  ds_read2_b32 v[74:75], v130 offset0:50 offset1:51
  ds_read2_b32 v[76:77], v131 offset0:48 offset1:49
  ds_read2_b32 v[78:79], v131 offset0:50 offset1:51
  ds_read2_b32 v[80:81], v132 offset0:48 offset1:49
  ds_read2_b32 v[82:83], v132 offset0:50 offset1:51
  ds_read2_b32 v[84:85], v133 offset0:48 offset1:49
  ds_read2_b32 v[86:87], v133 offset0:50 offset1:51
  ds_read2_b32 v[88:89], v134 offset0:48 offset1:49
  ds_read2_b32 v[90:91], v134 offset0:50 offset1:51
  ds_read2_b32 v[92:93], v135 offset0:48 offset1:49
  ds_read2_b32 v[94:95], v135 offset0:50 offset1:51
  s_waitcnt lgkmcnt(15)
  v_mfma_f32_16x16x32_bf16 v[60:63], v[64:67], v[124:127], 0
  ds_read_b128 v[124:127], v136 offset:3712
  v_mfma_f32_16x16x32_bf16 v[56:59], v[64:67], v[120:123], 0
  v_mfma_f32_16x16x32_bf16 v[52:55], v[64:67], v[116:119], 0
  v_mfma_f32_16x16x32_bf16 v[48:51], v[64:67], v[112:115], 0
  v_mfma_f32_16x16x32_bf16 v[44:47], v[64:67], v[108:111], 0
  v_mfma_f32_16x16x32_bf16 v[40:43], v[64:67], v[104:107], 0
  v_mfma_f32_16x16x32_bf16 v[36:39], v[64:67], v[100:103], 0
  s_waitcnt lgkmcnt(15)
  v_mfma_f32_16x16x32_bf16 v[32:35], v[64:67], v[96:99], 0
  ds_read2_b32 v[64:65], v128 offset0:32 offset1:33
  s_waitcnt lgkmcnt(14)
  v_mfma_f32_16x16x32_bf16 v[60:63], v[68:71], v[120:123], v[60:63]
  ds_read2_b32 v[66:67], v128 offset0:34 offset1:35
  v_mfma_f32_16x16x32_bf16 v[56:59], v[68:71], v[116:119], v[56:59]
  ds_read_b128 v[120:123], v136 offset:3200
  v_mfma_f32_16x16x32_bf16 v[52:55], v[68:71], v[112:115], v[52:55]
  v_mfma_f32_16x16x32_bf16 v[48:51], v[68:71], v[108:111], v[48:51]
  v_mfma_f32_16x16x32_bf16 v[44:47], v[68:71], v[104:107], v[44:47]
  v_mfma_f32_16x16x32_bf16 v[40:43], v[68:71], v[100:103], v[40:43]
  v_mfma_f32_16x16x32_bf16 v[36:39], v[68:71], v[96:99], v[36:39]
  ds_read2_b32 v[68:69], v129 offset0:32 offset1:33
  s_waitcnt lgkmcnt(15)
  v_mfma_f32_16x16x32_bf16 v[60:63], v[72:75], v[116:119], v[60:63]
  ds_read2_b32 v[70:71], v129 offset0:34 offset1:35
  v_mfma_f32_16x16x32_bf16 v[56:59], v[72:75], v[112:115], v[56:59]
  ds_read_b128 v[116:119], v136 offset:2688
  v_mfma_f32_16x16x32_bf16 v[52:55], v[72:75], v[108:111], v[52:55]
  v_mfma_f32_16x16x32_bf16 v[48:51], v[72:75], v[104:107], v[48:51]
  v_mfma_f32_16x16x32_bf16 v[44:47], v[72:75], v[100:103], v[44:47]
  v_mfma_f32_16x16x32_bf16 v[40:43], v[72:75], v[96:99], v[40:43]
  ds_read2_b32 v[72:73], v130 offset0:32 offset1:33
  s_waitcnt lgkmcnt(15)
  v_mfma_f32_16x16x32_bf16 v[60:63], v[76:79], v[112:115], v[60:63]
  ds_read2_b32 v[74:75], v130 offset0:34 offset1:35
  v_mfma_f32_16x16x32_bf16 v[56:59], v[76:79], v[108:111], v[56:59]
  ds_read_b128 v[112:115], v136 offset:2176
  v_mfma_f32_16x16x32_bf16 v[52:55], v[76:79], v[104:107], v[52:55]
  v_mfma_f32_16x16x32_bf16 v[48:51], v[76:79], v[100:103], v[48:51]
  v_mfma_f32_16x16x32_bf16 v[44:47], v[76:79], v[96:99], v[44:47]
  ds_read2_b32 v[76:77], v131 offset0:32 offset1:33
  s_waitcnt lgkmcnt(15)
  v_mfma_f32_16x16x32_bf16 v[60:63], v[80:83], v[108:111], v[60:63]
  ds_read2_b32 v[78:79], v131 offset0:34 offset1:35
  v_mfma_f32_16x16x32_bf16 v[56:59], v[80:83], v[104:107], v[56:59]
  ds_read_b128 v[108:111], v136 offset:1664
  v_mfma_f32_16x16x32_bf16 v[52:55], v[80:83], v[100:103], v[52:55]
  v_mfma_f32_16x16x32_bf16 v[48:51], v[80:83], v[96:99], v[48:51]
  ds_read2_b32 v[80:81], v132 offset0:32 offset1:33
  v_mfma_f32_16x16x32_bf16 v[60:63], v[84:87], v[104:107], v[60:63]
  ds_read2_b32 v[82:83], v132 offset0:34 offset1:35
  v_mfma_f32_16x16x32_bf16 v[56:59], v[84:87], v[100:103], v[56:59]
  ds_read_b128 v[104:107], v136 offset:1152
  v_mfma_f32_16x16x32_bf16 v[52:55], v[84:87], v[96:99], v[52:55]
  ds_read2_b32 v[84:85], v133 offset0:32 offset1:33
  s_waitcnt lgkmcnt(15)
  v_mfma_f32_16x16x32_bf16 v[60:63], v[88:91], v[100:103], v[60:63]
  ds_read2_b32 v[86:87], v133 offset0:34 offset1:35
  v_mfma_f32_16x16x32_bf16 v[56:59], v[88:91], v[96:99], v[56:59]
  ds_read_b128 v[100:103], v136 offset:640
  v_mfma_f32_16x16x32_bf16 v[60:63], v[92:95], v[96:99], v[60:63]
  ds_read2_b32 v[88:89], v134 offset0:32 offset1:33
  s_waitcnt lgkmcnt(15)
  v_mfma_f32_16x16x32_bf16 v[60:63], v[64:67], v[124:127], v[60:63]
  ds_read2_b32 v[90:91], v134 offset0:34 offset1:35
  v_mfma_f32_16x16x32_bf16 v[56:59], v[64:67], v[120:123], v[56:59]
  ds_read_b128 v[96:99], v136 offset:128
  s_waitcnt lgkmcnt(15)
  v_mfma_f32_16x16x32_bf16 v[52:55], v[64:67], v[116:119], v[52:55]
  ds_read2_b32 v[92:93], v135 offset0:32 offset1:33
  s_waitcnt lgkmcnt(13)
  v_mfma_f32_16x16x32_bf16 v[48:51], v[64:67], v[112:115], v[48:51]
  ds_read2_b32 v[94:95], v135 offset0:34 offset1:35
  s_waitcnt lgkmcnt(11)
  v_mfma_f32_16x16x32_bf16 v[44:47], v[64:67], v[108:111], v[44:47]
  ds_read_b128 v[124:127], v136 offset:3648
  s_waitcnt lgkmcnt(9)
  v_mfma_f32_16x16x32_bf16 v[40:43], v[64:67], v[104:107], v[40:43]
  s_waitcnt lgkmcnt(6)
  v_mfma_f32_16x16x32_bf16 v[36:39], v[64:67], v[100:103], v[36:39]
  s_waitcnt lgkmcnt(3)
  v_mfma_f32_16x16x32_bf16 v[32:35], v[64:67], v[96:99], v[32:35]
  ds_read2_b32 v[64:65], v128 offset0:16 offset1:17
  v_mfma_f32_16x16x32_bf16 v[60:63], v[68:71], v[120:123], v[60:63]
  ds_read2_b32 v[66:67], v128 offset0:18 offset1:19
  v_mfma_f32_16x16x32_bf16 v[56:59], v[68:71], v[116:119], v[56:59]
  ds_read_b128 v[120:123], v136 offset:3136
  v_mfma_f32_16x16x32_bf16 v[52:55], v[68:71], v[112:115], v[52:55]
  v_mfma_f32_16x16x32_bf16 v[48:51], v[68:71], v[108:111], v[48:51]
  v_mfma_f32_16x16x32_bf16 v[44:47], v[68:71], v[104:107], v[44:47]
  v_mfma_f32_16x16x32_bf16 v[40:43], v[68:71], v[100:103], v[40:43]
  v_mfma_f32_16x16x32_bf16 v[36:39], v[68:71], v[96:99], v[36:39]
  ds_read2_b32 v[68:69], v129 offset0:16 offset1:17
  v_mfma_f32_16x16x32_bf16 v[60:63], v[72:75], v[116:119], v[60:63]
  ds_read2_b32 v[70:71], v129 offset0:18 offset1:19
  v_mfma_f32_16x16x32_bf16 v[56:59], v[72:75], v[112:115], v[56:59]
  ds_read_b128 v[116:119], v136 offset:2624
  v_mfma_f32_16x16x32_bf16 v[52:55], v[72:75], v[108:111], v[52:55]
  v_mfma_f32_16x16x32_bf16 v[48:51], v[72:75], v[104:107], v[48:51]
  v_mfma_f32_16x16x32_bf16 v[44:47], v[72:75], v[100:103], v[44:47]
  v_mfma_f32_16x16x32_bf16 v[40:43], v[72:75], v[96:99], v[40:43]
  ds_read2_b32 v[72:73], v130 offset0:16 offset1:17
  v_mfma_f32_16x16x32_bf16 v[60:63], v[76:79], v[112:115], v[60:63]
  ds_read2_b32 v[74:75], v130 offset0:18 offset1:19
  v_mfma_f32_16x16x32_bf16 v[56:59], v[76:79], v[108:111], v[56:59]
  ds_read_b128 v[112:115], v136 offset:2112
  v_mfma_f32_16x16x32_bf16 v[52:55], v[76:79], v[104:107], v[52:55]
  v_mfma_f32_16x16x32_bf16 v[48:51], v[76:79], v[100:103], v[48:51]
  v_mfma_f32_16x16x32_bf16 v[44:47], v[76:79], v[96:99], v[44:47]
  ds_read2_b32 v[76:77], v131 offset0:16 offset1:17
  v_mfma_f32_16x16x32_bf16 v[60:63], v[80:83], v[108:111], v[60:63]
  ds_read2_b32 v[78:79], v131 offset0:18 offset1:19
  v_mfma_f32_16x16x32_bf16 v[56:59], v[80:83], v[104:107], v[56:59]
  ds_read_b128 v[108:111], v136 offset:1600
  v_mfma_f32_16x16x32_bf16 v[52:55], v[80:83], v[100:103], v[52:55]
  v_mfma_f32_16x16x32_bf16 v[48:51], v[80:83], v[96:99], v[48:51]
  ds_read2_b32 v[80:81], v132 offset0:16 offset1:17
  v_mfma_f32_16x16x32_bf16 v[60:63], v[84:87], v[104:107], v[60:63]
  ds_read2_b32 v[82:83], v132 offset0:18 offset1:19
  v_mfma_f32_16x16x32_bf16 v[56:59], v[84:87], v[100:103], v[56:59]
  ds_read_b128 v[104:107], v136 offset:1088
  v_mfma_f32_16x16x32_bf16 v[52:55], v[84:87], v[96:99], v[52:55]
  ds_read2_b32 v[84:85], v133 offset0:16 offset1:17
  v_mfma_f32_16x16x32_bf16 v[60:63], v[88:91], v[100:103], v[60:63]
  ds_read2_b32 v[86:87], v133 offset0:18 offset1:19
  v_mfma_f32_16x16x32_bf16 v[56:59], v[88:91], v[96:99], v[56:59]
  ds_read_b128 v[100:103], v136 offset:576
  s_waitcnt lgkmcnt(15)
  v_mfma_f32_16x16x32_bf16 v[60:63], v[92:95], v[96:99], v[60:63]
  ds_read2_b32 v[88:89], v134 offset0:16 offset1:17
  v_mfma_f32_16x16x32_bf16 v[60:63], v[64:67], v[124:127], v[60:63]
  ds_read2_b32 v[90:91], v134 offset0:18 offset1:19
  v_mfma_f32_16x16x32_bf16 v[56:59], v[64:67], v[120:123], v[56:59]
  ds_read_b128 v[96:99], v136 offset:64
  s_waitcnt lgkmcnt(15)
  v_mfma_f32_16x16x32_bf16 v[52:55], v[64:67], v[116:119], v[52:55]
  ds_read2_b32 v[92:93], v135 offset0:16 offset1:17
  s_waitcnt lgkmcnt(13)
  v_mfma_f32_16x16x32_bf16 v[48:51], v[64:67], v[112:115], v[48:51]
  ds_read2_b32 v[94:95], v135 offset0:18 offset1:19
  s_waitcnt lgkmcnt(11)
  v_mfma_f32_16x16x32_bf16 v[44:47], v[64:67], v[108:111], v[44:47]
  ds_read_b128 v[124:127], v136 offset:3584
  s_waitcnt lgkmcnt(9)
  v_mfma_f32_16x16x32_bf16 v[40:43], v[64:67], v[104:107], v[40:43]
  s_waitcnt lgkmcnt(6)
  v_mfma_f32_16x16x32_bf16 v[36:39], v[64:67], v[100:103], v[36:39]
  s_waitcnt lgkmcnt(3)
  v_mfma_f32_16x16x32_bf16 v[32:35], v[64:67], v[96:99], v[32:35]
  ds_read2_b32 v[64:65], v128 offset0:0 offset1:1
  v_mfma_f32_16x16x32_bf16 v[60:63], v[68:71], v[120:123], v[60:63]
  ds_read2_b32 v[66:67], v128 offset0:2 offset1:3
  v_mfma_f32_16x16x32_bf16 v[56:59], v[68:71], v[116:119], v[56:59]
  ds_read_b128 v[120:123], v136 offset:3072
  v_mfma_f32_16x16x32_bf16 v[52:55], v[68:71], v[112:115], v[52:55]
  v_mfma_f32_16x16x32_bf16 v[48:51], v[68:71], v[108:111], v[48:51]
  v_mfma_f32_16x16x32_bf16 v[44:47], v[68:71], v[104:107], v[44:47]
  v_mfma_f32_16x16x32_bf16 v[40:43], v[68:71], v[100:103], v[40:43]
  v_mfma_f32_16x16x32_bf16 v[36:39], v[68:71], v[96:99], v[36:39]
  ds_read2_b32 v[68:69], v129 offset0:0 offset1:1
  v_mfma_f32_16x16x32_bf16 v[60:63], v[72:75], v[116:119], v[60:63]
  ds_read2_b32 v[70:71], v129 offset0:2 offset1:3
  v_mfma_f32_16x16x32_bf16 v[56:59], v[72:75], v[112:115], v[56:59]
  ds_read_b128 v[116:119], v136 offset:2560
  v_mfma_f32_16x16x32_bf16 v[52:55], v[72:75], v[108:111], v[52:55]
  v_mfma_f32_16x16x32_bf16 v[48:51], v[72:75], v[104:107], v[48:51]
  v_mfma_f32_16x16x32_bf16 v[44:47], v[72:75], v[100:103], v[44:47]
  v_mfma_f32_16x16x32_bf16 v[40:43], v[72:75], v[96:99], v[40:43]
  ds_read2_b32 v[72:73], v130 offset0:0 offset1:1
  v_mfma_f32_16x16x32_bf16 v[60:63], v[76:79], v[112:115], v[60:63]
  ds_read2_b32 v[74:75], v130 offset0:2 offset1:3
  v_mfma_f32_16x16x32_bf16 v[56:59], v[76:79], v[108:111], v[56:59]
  ds_read_b128 v[112:115], v136 offset:2048
  v_mfma_f32_16x16x32_bf16 v[52:55], v[76:79], v[104:107], v[52:55]
  v_mfma_f32_16x16x32_bf16 v[48:51], v[76:79], v[100:103], v[48:51]
  v_mfma_f32_16x16x32_bf16 v[44:47], v[76:79], v[96:99], v[44:47]
  ds_read2_b32 v[76:77], v131 offset0:0 offset1:1
  v_mfma_f32_16x16x32_bf16 v[60:63], v[80:83], v[108:111], v[60:63]
  ds_read2_b32 v[78:79], v131 offset0:2 offset1:3
  v_mfma_f32_16x16x32_bf16 v[56:59], v[80:83], v[104:107], v[56:59]
  ds_read_b128 v[108:111], v136 offset:1536
  v_mfma_f32_16x16x32_bf16 v[52:55], v[80:83], v[100:103], v[52:55]
  v_mfma_f32_16x16x32_bf16 v[48:51], v[80:83], v[96:99], v[48:51]
  ds_read2_b32 v[80:81], v132 offset0:0 offset1:1
  v_mfma_f32_16x16x32_bf16 v[60:63], v[84:87], v[104:107], v[60:63]
  ds_read2_b32 v[82:83], v132 offset0:2 offset1:3
  v_mfma_f32_16x16x32_bf16 v[56:59], v[84:87], v[100:103], v[56:59]
  ds_read_b128 v[104:107], v136 offset:1024
  v_mfma_f32_16x16x32_bf16 v[52:55], v[84:87], v[96:99], v[52:55]
  ds_read2_b32 v[84:85], v133 offset0:0 offset1:1
  v_mfma_f32_16x16x32_bf16 v[60:63], v[88:91], v[100:103], v[60:63]
  ds_read2_b32 v[86:87], v133 offset0:2 offset1:3
  v_mfma_f32_16x16x32_bf16 v[56:59], v[88:91], v[96:99], v[56:59]
  ds_read_b128 v[100:103], v136 offset:512
  s_waitcnt lgkmcnt(15)
  v_mfma_f32_16x16x32_bf16 v[60:63], v[92:95], v[96:99], v[60:63]
  ds_read2_b32 v[88:89], v134 offset0:0 offset1:1
  v_mfma_f32_16x16x32_bf16 v[60:63], v[64:67], v[124:127], v[60:63]
  ds_read2_b32 v[90:91], v134 offset0:2 offset1:3
  v_mfma_f32_16x16x32_bf16 v[56:59], v[64:67], v[120:123], v[56:59]
  ds_read_b128 v[96:99], v136 offset:0
  s_waitcnt lgkmcnt(15)
  v_mfma_f32_16x16x32_bf16 v[52:55], v[64:67], v[116:119], v[52:55]
  ds_read2_b32 v[92:93], v135 offset0:0 offset1:1
  s_waitcnt lgkmcnt(13)
  v_mfma_f32_16x16x32_bf16 v[48:51], v[64:67], v[112:115], v[48:51]
  ds_read2_b32 v[94:95], v135 offset0:2 offset1:3
  s_waitcnt lgkmcnt(11)
  v_mfma_f32_16x16x32_bf16 v[44:47], v[64:67], v[108:111], v[44:47]
  s_waitcnt lgkmcnt(8)
  v_mfma_f32_16x16x32_bf16 v[40:43], v[64:67], v[104:107], v[40:43]
  s_waitcnt lgkmcnt(5)
  v_mfma_f32_16x16x32_bf16 v[36:39], v[64:67], v[100:103], v[36:39]
  s_waitcnt lgkmcnt(2)
  v_mfma_f32_16x16x32_bf16 v[32:35], v[64:67], v[96:99], v[32:35]
  v_mfma_f32_16x16x32_bf16 v[60:63], v[68:71], v[120:123], v[60:63]
  v_mfma_f32_16x16x32_bf16 v[56:59], v[68:71], v[116:119], v[56:59]
  v_mfma_f32_16x16x32_bf16 v[52:55], v[68:71], v[112:115], v[52:55]
  v_mfma_f32_16x16x32_bf16 v[48:51], v[68:71], v[108:111], v[48:51]
  v_mfma_f32_16x16x32_bf16 v[44:47], v[68:71], v[104:107], v[44:47]
  v_mfma_f32_16x16x32_bf16 v[40:43], v[68:71], v[100:103], v[40:43]
  v_mfma_f32_16x16x32_bf16 v[36:39], v[68:71], v[96:99], v[36:39]
  v_mfma_f32_16x16x32_bf16 v[60:63], v[72:75], v[116:119], v[60:63]
  v_mfma_f32_16x16x32_bf16 v[56:59], v[72:75], v[112:115], v[56:59]
  v_mfma_f32_16x16x32_bf16 v[52:55], v[72:75], v[108:111], v[52:55]
  v_mfma_f32_16x16x32_bf16 v[48:51], v[72:75], v[104:107], v[48:51]
  v_mfma_f32_16x16x32_bf16 v[44:47], v[72:75], v[100:103], v[44:47]
  v_mfma_f32_16x16x32_bf16 v[40:43], v[72:75], v[96:99], v[40:43]
  v_mfma_f32_16x16x32_bf16 v[60:63], v[76:79], v[112:115], v[60:63]
  v_mfma_f32_16x16x32_bf16 v[56:59], v[76:79], v[108:111], v[56:59]
  v_mfma_f32_16x16x32_bf16 v[52:55], v[76:79], v[104:107], v[52:55]
  v_mfma_f32_16x16x32_bf16 v[48:51], v[76:79], v[100:103], v[48:51]
  v_mfma_f32_16x16x32_bf16 v[44:47], v[76:79], v[96:99], v[44:47]
  v_mfma_f32_16x16x32_bf16 v[60:63], v[80:83], v[108:111], v[60:63]
  v_mfma_f32_16x16x32_bf16 v[56:59], v[80:83], v[104:107], v[56:59]
  v_mfma_f32_16x16x32_bf16 v[52:55], v[80:83], v[100:103], v[52:55]
  v_mfma_f32_16x16x32_bf16 v[48:51], v[80:83], v[96:99], v[48:51]
  v_mfma_f32_16x16x32_bf16 v[60:63], v[84:87], v[104:107], v[60:63]
  v_mfma_f32_16x16x32_bf16 v[56:59], v[84:87], v[100:103], v[56:59]
  v_mfma_f32_16x16x32_bf16 v[52:55], v[84:87], v[96:99], v[52:55]
  v_mfma_f32_16x16x32_bf16 v[60:63], v[88:91], v[100:103], v[60:63]
  v_mfma_f32_16x16x32_bf16 v[56:59], v[88:91], v[96:99], v[56:59]
  s_waitcnt lgkmcnt(0)
  v_mfma_f32_16x16x32_bf16 v[60:63], v[92:95], v[96:99], v[60:63]
  v_mov_b32 v3, 163432
  s_waitcnt lgkmcnt(0)
  s_mov_b32 s88, 0
L_lw_17:
  ds_read_b32 v4, v3
  s_waitcnt lgkmcnt(0)
  v_readfirstlane_b32 s82, v4
  s_nop 0
  s_cmp_ge_u32 s82, 4
  s_cbranch_scc1 L_ld_18
  s_nop 0
  s_add_u32 s88, s88, 1
  s_cmp_gt_u32 s88, 0x100000
  s_cbranch_scc0 L_lw_17
L_ld_18:
  s_lshl_b32 s70, s64, 12
  s_add_u32 s70, s70, 98304
  v_lshl_add_u32 v128, v1, 4, s70
  s_xor_b32 s71, s64, 1
  s_lshl_b32 s73, s71, 12
  s_add_u32 s73, s73, 98304
  v_lshl_add_u32 v129, v1, 4, s73
  s_lshl_b32 s73, s64, 2
  s_add_u32 s73, s73, 163472
  v_mov_b32 v130, s73
  s_lshl_b32 s73, s71, 2
  s_add_u32 s73, s73, 163472
  v_mov_b32 v131, s73
  v_mov_b32 v132, 1
  s_and_b32 s72, s64, 1
  s_waitcnt lgkmcnt(0)
  s_cmp_eq_u32 s72, 1
  s_cbranch_scc1 L_cv_odd_19
  ds_write_b128 v128, v[48:51] offset:0
  ds_write_b128 v128, v[52:55] offset:1024
  ds_write_b128 v128, v[56:59] offset:2048
  ds_write_b128 v128, v[60:63] offset:3072
  v_mov_b32 v64, v32
  v_mov_b32 v65, v33
  v_mov_b32 v66, v34
  v_mov_b32 v67, v35
  v_mov_b32 v68, v36
  v_mov_b32 v69, v37
  v_mov_b32 v70, v38
  v_mov_b32 v71, v39
  v_mov_b32 v72, v40
  v_mov_b32 v73, v41
  v_mov_b32 v74, v42
  v_mov_b32 v75, v43
  v_mov_b32 v76, v44
  v_mov_b32 v77, v45
  v_mov_b32 v78, v46
  v_mov_b32 v79, v47
  s_branch L_cv_join_20
L_cv_odd_19:
  ds_write_b128 v128, v[32:35] offset:0
  ds_write_b128 v128, v[36:39] offset:1024
  ds_write_b128 v128, v[40:43] offset:2048
  ds_write_b128 v128, v[44:47] offset:3072
  v_mov_b32 v64, v48
  v_mov_b32 v65, v49
  v_mov_b32 v66, v50
  v_mov_b32 v67, v51
  v_mov_b32 v68, v52
  v_mov_b32 v69, v53
  v_mov_b32 v70, v54
  v_mov_b32 v71, v55
  v_mov_b32 v72, v56
  v_mov_b32 v73, v57
  v_mov_b32 v74, v58
  v_mov_b32 v75, v59
  v_mov_b32 v76, v60
  v_mov_b32 v77, v61
  v_mov_b32 v78, v62
  v_mov_b32 v79, v63
L_cv_join_20:
  s_waitcnt lgkmcnt(0)
  ds_write_b32 v130, v132
  s_waitcnt lgkmcnt(0)
  s_mov_b32 s88, 0
L_lw_21:
  ds_read_b32 v133, v131
  s_waitcnt lgkmcnt(0)
  v_readfirstlane_b32 s82, v133
  s_nop 0
  s_cmp_ge_u32 s82, 1
  s_cbranch_scc1 L_ld_22
  s_sleep 1
  s_add_u32 s88, s88, 1
  s_cmp_gt_u32 s88, 0x100000
  s_cbranch_scc0 L_lw_21
L_ld_22:
  ds_read_b128 v[96:99], v129 offset:0
  ds_read_b128 v[100:103], v129 offset:1024
  ds_read_b128 v[104:107], v129 offset:2048
  ds_read_b128 v[108:111], v129 offset:3072
  s_lshl_b32 s70, s2, 1
  s_lshr_b32 s71, s64, 1
  s_add_u32 s70, s70, s71
  s_lshl_b32 s70, s70, 12
  s_lshl_b32 s72, s72, 11
  s_add_u32 s70, s70, s72
  s_add_u32 s70, s70, 5242880
  v_and_b32 v128, 15, v1
  v_lshlrev_b32 v128, 5, v128
  v_lshrrev_b32 v129, 4, v1
  v_lshl_add_u32 v128, v129, 3, v128
  s_waitcnt lgkmcnt(3)
  v_pk_add_f32 v[64:65], v[64:65], v[96:97]
  v_pk_add_f32 v[66:67], v[66:67], v[98:99]
  v_cvt_pk_bf16_f32 v32, v64, v65
  v_cvt_pk_bf16_f32 v33, v66, v67
  buffer_store_dwordx2 v[32:33], v128, s[52:55], s70 offen offset:0 sc1
  s_waitcnt lgkmcnt(2)
  v_pk_add_f32 v[68:69], v[68:69], v[100:101]
  v_pk_add_f32 v[70:71], v[70:71], v[102:103]
  v_cvt_pk_bf16_f32 v34, v68, v69
  v_cvt_pk_bf16_f32 v35, v70, v71
  buffer_store_dwordx2 v[34:35], v128, s[52:55], s70 offen offset:512 sc1
  s_waitcnt lgkmcnt(1)
  v_pk_add_f32 v[72:73], v[72:73], v[104:105]
  v_pk_add_f32 v[74:75], v[74:75], v[106:107]
  v_cvt_pk_bf16_f32 v36, v72, v73
  v_cvt_pk_bf16_f32 v37, v74, v75
  buffer_store_dwordx2 v[36:37], v128, s[52:55], s70 offen offset:1024 sc1
  s_waitcnt lgkmcnt(0)
  v_pk_add_f32 v[76:77], v[76:77], v[108:109]
  v_pk_add_f32 v[78:79], v[78:79], v[110:111]
  v_cvt_pk_bf16_f32 v38, v76, v77
  v_cvt_pk_bf16_f32 v39, v78, v79
  buffer_store_dwordx2 v[38:39], v128, s[52:55], s70 offen offset:1536 sc1
  v_mov_b32 v3, 163428
  v_mov_b32 v4, 1
  s_mov_b64 exec, 1
  ds_add_u32 v3, v4
  s_waitcnt vmcnt(0)
  s_lshr_b32 s78, s2, 5
  s_lshl_b32 s78, s78, 1
  s_and_b32 s79, s64, 1
  s_add_u32 s78, s78, s79
  s_lshl_b32 s78, s78, 6
  s_and_b32 s79, s2, 31
  s_lshl_b32 s79, s79, 1
  s_add_u32 s78, s78, s79
  s_lshr_b32 s79, s64, 1
  s_add_u32 s78, s78, s79
  s_lshl_b32 s78, s78, 2
  s_add_u32 s78, s78, 5120
  v_mov_b32 v3, 1
  v_mov_b32 v4, s78
  buffer_store_dword v3, v4, s[52:55], 0 offen sc1
  s_mov_b64 exec, -1
  s_branch L_end
L_main:
  s_setprio 2
  s_waitcnt lgkmcnt(0)
  s_mov_b32 s40, s4
  s_and_b32 s41, s5, 0xffff
  s_mov_b32 s42, 2097152
  s_mov_b32 s43, 0x00020000
  s_mov_b32 s52, s36
  s_and_b32 s53, s37, 0xffff
  s_mov_b32 s54, 268435456
  s_mov_b32 s55, 0x00020000
  s_mov_b32 s60, s34
  s_and_b32 s61, s35, 0xffff
  s_mov_b32 s62, 256
  s_mov_b32 s63, 0x00020000
  s_mov_b32 s48, s28
  s_and_b32 s49, s29, 0xffff
  s_mov_b32 s50, 1835008
  s_mov_b32 s51, 0x00020000
  s_mov_b32 s56, s32
  s_and_b32 s57, s33, 0xffff
  s_mov_b32 s58, 2097152
  s_mov_b32 s59, 0x00020000
  v_mov_b32 v4, 0
  v_mov_b32 v5, 0
  v_mov_b32 v6, 0
  v_mov_b32 v7, 0
  v_lshlrev_b32 v3, 4, v1
  s_or_b32 s70, s2, s64
  s_cmp_lg_u32 s70, 0
  s_cbranch_scc1 L_g_23
  buffer_store_dwordx4 v[4:7], v3, s[52:55], 0 offen offset:0 sc1
  buffer_store_dwordx4 v[4:7], v3, s[52:55], 0 offen offset:1024 sc1
  buffer_store_dwordx4 v[4:7], v3, s[52:55], 0 offen offset:2048 sc1
  buffer_store_dwordx4 v[4:7], v3, s[52:55], 0 offen offset:3072 sc1
  v_add_u32 v3, 4096, v3
  buffer_store_dwordx4 v[4:7], v3, s[52:55], 0 offen offset:0 sc1
  buffer_store_dwordx4 v[4:7], v3, s[52:55], 0 offen offset:1024 sc1
  buffer_store_dwordx4 v[4:7], v3, s[52:55], 0 offen offset:2048 sc1
  buffer_store_dwordx4 v[4:7], v3, s[52:55], 0 offen offset:3072 sc1
  v_add_u32 v3, 4096, v3
  buffer_store_dwordx4 v[4:7], v3, s[52:55], 0 offen offset:0 sc1
L_g_23:
  v_lshlrev_b32 v3, 2, v1
  v_and_b32 v3, 127, v3
  v_add_u32 v3, 163424, v3
  v_mov_b32 v4, 0
  ds_write_b32 v3, v4
  s_cmp_ge_u32 s66, 28
  s_cbranch_scc1 L_spare
  s_lshl_b32 s70, s68, 7
  s_and_b32 s71, s64, 1
  s_lshl_b32 s71, s71, 6
  s_add_u32 s70, s70, s71
  s_lshl_b32 s70, s70, 1
  v_lshrrev_b32 v112, 5, v1
  v_lshl_add_u32 v112, v112, 3, s70
  global_load_dwordx2 v[96:97], v112, s[26:27] offset:0
  global_load_dwordx2 v[98:99], v112, s[26:27] offset:16
  global_load_dwordx2 v[100:101], v112, s[26:27] offset:32
  global_load_dwordx2 v[102:103], v112, s[26:27] offset:48
  global_load_dwordx2 v[104:105], v112, s[26:27] offset:64
  global_load_dwordx2 v[106:107], v112, s[26:27] offset:80
  global_load_dwordx2 v[108:109], v112, s[26:27] offset:96
  global_load_dwordx2 v[110:111], v112, s[26:27] offset:112
  v_lshrrev_b32 v30, 3, v1
  v_lshlrev_b32 v30, 10, v30
  v_and_b32 v31, 7, v1
  v_lshl_add_u32 v30, v31, 4, v30
  s_lshl_b32 s70, s66, 6
  s_lshl_b32 s71, s64, 4
  s_add_u32 s70, s70, s71
  s_lshl_b32 s70, s70, 10
  s_lshl_b32 s71, s65, 7
  s_add_u32 s70, s70, s71
  s_add_u32 s71, s70, 8192
  buffer_load_dwordx4 v[22:25], v30, s[40:43], s70 offen
  buffer_load_dwordx4 v[26:29], v30, s[40:43], s71 offen
  s_lshl_b32 s70, s2, 2
  s_add_u32 s70, s70, s64
  s_lshl_b32 s70, s70, 7
  v_lshl_add_u32 v21, v1, 1, s70
  global_load_ushort v8, v21, s[6:7]
  global_load_ushort v9, v21, s[8:9]
  global_load_ushort v10, v21, s[10:11]
  global_load_ushort v11, v21, s[12:13]
  global_load_ushort v12, v21, s[14:15]
  global_load_ushort v13, v21, s[16:17]
  s_lshr_b32 s70, s64, 1
  s_lshl_b32 s71, s2, 1
  s_add_u32 s70, s70, s71
  s_lshl_b32 s70, s70, 1
  v_mov_b32 v21, s70
  global_load_ushort v14, v21, s[18:19]
  global_load_ushort v15, v21, s[20:21]
  s_getpc_b64 s[72:73]
L_pc_24:
  s_add_u32 s72, s72, L_gtab-L_pc_24
  s_addc_u32 s73, s73, 0
  v_lshlrev_b32 v21, 4, v2
  global_load_dwordx4 v[16:19], v21, s[72:73]
  global_load_ushort v20, v21, s[72:73] offset:16
  v_and_b32 v140, 31, v1
  v_bfe_u32 v143, v1, 4, 1
  v_lshrrev_b32 v142, 5, v1
  v_lshrrev_b32 v141, 1, v140
  v_and_b32 v141, 7, v141
  v_xor_b32 v141, v141, v142
  s_lshr_b32 s70, s64, 1
  s_lshl_b32 s70, s70, 6
  v_add_u32 v140, s70, v140
  v_lshlrev_b32 v140, 7, v140
  v_lshl_add_u32 v128, v141, 4, v140
  v_xor_b32 v129, 32, v128
  v_xor_b32 v130, 64, v128
  v_xor_b32 v131, 96, v128
  v_bfe_u32 v140, v1, 2, 2
  v_lshl_add_u32 v141, v142, 3, v140
  v_lshlrev_b32 v141, 8, v141
  s_and_b32 s70, s64, 1
  s_lshl_b32 s70, s70, 1
  v_xor_b32 v140, s70, v140
  v_lshlrev_b32 v140, 2, v140
  v_lshl_add_u32 v140, v143, 1, v140
  v_bfe_u32 v142, v1, 1, 1
  v_add_u32 v140, v140, v142
  v_lshl_add_u32 v141, v140, 4, v141
  v_and_b32 v142, 1, v1
  v_lshl_add_u32 v141, v142, 3, v141
  v_add_u32 v132, 16384, v141
  v_xor_b32 v133, 64, v132
  s_mov_b32 s92, 0
  s_mov_b32 s94, 0
  s_lshr_b32 s70, s66, 3
  s_lshl_b32 s95, s65, 2
  s_add_u32 s95, s95, s70
  s_and_b32 s96, s66, 7
  s_mul_i32 s70, s64, 458752
  s_lshl_b32 s71, s96, 7
  s_add_u32 s97, s70, s71
  s_lshr_b32 s70, s64, 1
  s_lshl_b32 s71, s95, 1
  s_add_u32 s72, s71, s70
  s_xor_b32 s70, s70, 1
  s_add_u32 s73, s71, s70
  s_mul_i32 s70, s64, 28
  s_mul_i32 s72, s72, 128
  s_mul_i32 s73, s73, 128
  s_add_u32 s72, s72, s70
  s_add_u32 s73, s73, s70
  s_lshl_b32 s72, s72, 10
  s_lshl_b32 s73, s73, 10
  s_add_u32 s98, s72, 8388608
  s_add_u32 s99, s73, 8388608
  s_mul_i32 s70, s96, 7
  s_lshr_b32 s70, s70, 1
  s_and_b32 s71, s95, 3
  s_mul_i32 s71, s71, 7
  s_add_u32 s70, s70, s71
  s_cmp_ge_u32 s70, 28
  s_cselect_b32 s71, 28, 0
  s_sub_u32 s70, s70, s71
  s_lshl_b32 s70, s70, 10
  s_mov_b32 s4, s70
  s_add_u32 s70, s70, 1024
  s_cmp_eq_u32 s70, 28672
  s_cselect_b32 s70, 0, s70
  s_mov_b32 s5, s70
  s_add_u32 s70, s70, 1024
  s_cmp_eq_u32 s70, 28672
  s_cselect_b32 s70, 0, s70
  s_mov_b32 s6, s70
  s_add_u32 s70, s70, 1024
  s_cmp_eq_u32 s70, 28672
  s_cselect_b32 s70, 0, s70
  s_mov_b32 s7, s70
  s_add_u32 s70, s70, 1024
  s_cmp_eq_u32 s70, 28672
  s_cselect_b32 s70, 0, s70
  s_mov_b32 s8, s70
  s_add_u32 s70, s70, 1024
  s_cmp_eq_u32 s70, 28672
  s_cselect_b32 s70, 0, s70
  s_mov_b32 s9, s70
  s_add_u32 s70, s70, 1024
  s_cmp_eq_u32 s70, 28672
  s_cselect_b32 s70, 0, s70
  s_mov_b32 s10, s70
  s_add_u32 s70, s70, 1024
  s_cmp_eq_u32 s70, 28672
  s_cselect_b32 s70, 0, s70
  s_mov_b32 s11, s70
  s_add_u32 s70, s70, 1024
  s_cmp_eq_u32 s70, 28672
  s_cselect_b32 s70, 0, s70
  s_mov_b32 s12, s70
  s_add_u32 s70, s70, 1024
  s_cmp_eq_u32 s70, 28672
  s_cselect_b32 s70, 0, s70
  s_mov_b32 s13, s70
  s_add_u32 s70, s70, 1024
  s_cmp_eq_u32 s70, 28672
  s_cselect_b32 s70, 0, s70
  s_mov_b32 s14, s70
  s_add_u32 s70, s70, 1024
  s_cmp_eq_u32 s70, 28672
  s_cselect_b32 s70, 0, s70
  s_mov_b32 s15, s70
  s_add_u32 s70, s70, 1024
  s_cmp_eq_u32 s70, 28672
  s_cselect_b32 s70, 0, s70
  s_mov_b32 s16, s70
  s_add_u32 s70, s70, 1024
  s_cmp_eq_u32 s70, 28672
  s_cselect_b32 s70, 0, s70
  s_mov_b32 s17, s70
  s_add_u32 s70, s70, 1024
  s_cmp_eq_u32 s70, 28672
  s_cselect_b32 s70, 0, s70
  s_mov_b32 s18, s70
  s_add_u32 s70, s70, 1024
  s_cmp_eq_u32 s70, 28672
  s_cselect_b32 s70, 0, s70
  s_mov_b32 s19, s70
  s_add_u32 s70, s70, 1024
  s_cmp_eq_u32 s70, 28672
  s_cselect_b32 s70, 0, s70
  s_mov_b32 s20, s70
  s_add_u32 s70, s70, 1024
  s_cmp_eq_u32 s70, 28672
  s_cselect_b32 s70, 0, s70
  s_mov_b32 s21, s70
  s_add_u32 s70, s70, 1024
  s_cmp_eq_u32 s70, 28672
  s_cselect_b32 s70, 0, s70
  s_mov_b32 s22, s70
  s_add_u32 s70, s70, 1024
  s_cmp_eq_u32 s70, 28672
  s_cselect_b32 s70, 0, s70
  s_mov_b32 s23, s70
  s_add_u32 s70, s70, 1024
  s_cmp_eq_u32 s70, 28672
  s_cselect_b32 s70, 0, s70
  s_mov_b32 s24, s70
  s_add_u32 s70, s70, 1024
  s_cmp_eq_u32 s70, 28672
  s_cselect_b32 s70, 0, s70
  s_mov_b32 s25, s70
  s_add_u32 s70, s70, 1024
  s_cmp_eq_u32 s70, 28672
  s_cselect_b32 s70, 0, s70
  s_mov_b32 s26, s70
  s_add_u32 s70, s70, 1024
  s_cmp_eq_u32 s70, 28672
  s_cselect_b32 s70, 0, s70
  s_mov_b32 s27, s70
  s_add_u32 s70, s70, 1024
  s_cmp_eq_u32 s70, 28672
  s_cselect_b32 s70, 0, s70
  s_mov_b32 s28, s70
  s_add_u32 s70, s70, 1024
  s_cmp_eq_u32 s70, 28672
  s_cselect_b32 s70, 0, s70
  s_mov_b32 s29, s70
  s_add_u32 s70, s70, 1024
  s_cmp_eq_u32 s70, 28672
  s_cselect_b32 s70, 0, s70
  s_mov_b32 s30, s70
  s_add_u32 s70, s70, 1024
  s_cmp_eq_u32 s70, 28672
  s_cselect_b32 s70, 0, s70
  s_mov_b32 s31, s70
  s_add_u32 s70, s70, 1024
  s_cmp_eq_u32 s70, 28672
  s_cselect_b32 s70, 0, s70
  v_lshrrev_b32 v4, 3, v1
  v_bfe_u32 v5, v1, 4, 1
  v_lshlrev_b32 v5, 2, v5
  v_and_b32 v6, 7, v1
  v_xor_b32 v5, v5, v6
  v_lshlrev_b32 v4, 10, v4
  v_lshl_add_u32 v144, v5, 4, v4
  v_add_u32 v144, s97, v144
  v_add_u32 v145, 7168, v144
  s_mul_i32 s89, s64, 24576
  v_lshlrev_b32 v147, 4, v1
  v_add_u32 v146, s98, v147
  v_add_u32 v147, s99, v147
  v_bfe_u32 v4, v1, 2, 2
  v_lshrrev_b32 v5, 5, v1
  v_lshl_add_u32 v5, v5, 2, v4
  v_lshlrev_b32 v5, 7, v5
  v_lshrrev_b32 v4, 1, v4
  s_and_b32 s70, s64, 1
  v_xor_b32 v4, s70, v4
  v_lshl_add_u32 v5, v4, 6, v5
  v_bfe_u32 v4, v1, 4, 1
  v_lshl_add_u32 v5, v4, 5, v5
  v_and_b32 v4, 3, v1
  v_lshl_add_u32 v5, v4, 3, v5
  v_add_u32 v148, s89, v5
  v_xor_b32 v149, 64, v148
  s_waitcnt vmcnt(19)
  v_lshlrev_b32 v32, 16, v96
  v_and_b32 v33, 0xffff0000, v96
  v_lshlrev_b32 v34, 16, v97
  v_and_b32 v35, 0xffff0000, v97
  s_waitcnt vmcnt(18)
  v_lshlrev_b32 v36, 16, v98
  v_and_b32 v37, 0xffff0000, v98
  v_lshlrev_b32 v38, 16, v99
  v_and_b32 v39, 0xffff0000, v99
  s_waitcnt vmcnt(17)
  v_lshlrev_b32 v40, 16, v100
  v_and_b32 v41, 0xffff0000, v100
  v_lshlrev_b32 v42, 16, v101
  v_and_b32 v43, 0xffff0000, v101
  s_waitcnt vmcnt(16)
  v_lshlrev_b32 v44, 16, v102
  v_and_b32 v45, 0xffff0000, v102
  v_lshlrev_b32 v46, 16, v103
  v_and_b32 v47, 0xffff0000, v103
  s_waitcnt vmcnt(15)
  v_lshlrev_b32 v64, 16, v104
  v_and_b32 v65, 0xffff0000, v104
  v_lshlrev_b32 v66, 16, v105
  v_and_b32 v67, 0xffff0000, v105
  s_waitcnt vmcnt(14)
  v_lshlrev_b32 v68, 16, v106
  v_and_b32 v69, 0xffff0000, v106
  v_lshlrev_b32 v70, 16, v107
  v_and_b32 v71, 0xffff0000, v107
  s_waitcnt vmcnt(13)
  v_lshlrev_b32 v72, 16, v108
  v_and_b32 v73, 0xffff0000, v108
  v_lshlrev_b32 v74, 16, v109
  v_and_b32 v75, 0xffff0000, v109
  s_waitcnt vmcnt(12)
  v_lshlrev_b32 v76, 16, v110
  v_and_b32 v77, 0xffff0000, v110
  v_lshlrev_b32 v78, 16, v111
  v_and_b32 v79, 0xffff0000, v111
  v_mov_b64 v[48:49], v[32:33]
  v_mov_b64 v[50:51], v[34:35]
  v_mov_b64 v[52:53], v[36:37]
  v_mov_b64 v[54:55], v[38:39]
  v_mov_b64 v[56:57], v[40:41]
  v_mov_b64 v[58:59], v[42:43]
  v_mov_b64 v[60:61], v[44:45]
  v_mov_b64 v[62:63], v[46:47]
  v_mov_b64 v[80:81], v[64:65]
  v_mov_b64 v[82:83], v[66:67]
  v_mov_b64 v[84:85], v[68:69]
  v_mov_b64 v[86:87], v[70:71]
  v_mov_b64 v[88:89], v[72:73]
  v_mov_b64 v[90:91], v[74:75]
  v_mov_b64 v[92:93], v[76:77]
  v_mov_b64 v[94:95], v[78:79]
  v_lshrrev_b32 v30, 3, v1
  v_mul_u32_u24 v30, 144, v30
  v_and_b32 v31, 7, v1
  v_lshl_add_u32 v30, v31, 4, v30
  s_mul_i32 s70, s64, 2304
  s_add_u32 s70, s70, 131072
  v_add_u32 v30, s70, v30
  s_waitcnt vmcnt(11)
  ds_write_b128 v30, v[22:25]
  s_waitcnt vmcnt(10)
  ds_write_b128 v30, v[26:29] offset:1152
  s_or_b32 s70, s2, s64
  s_cmp_lg_u32 s70, 0
  s_cbranch_scc1 L_g_25
  s_mov_b64 exec, 1
  v_mov_b32 v4, 1
  v_mov_b32 v3, 32
  buffer_store_dword v4, v3, s[60:63], 0 offen sc1
  s_mov_b64 exec, -1
L_g_25:
  v_lshlrev_b32 v3, 2, v2
  v_add_u32 v3, 141312, v3
  s_waitcnt vmcnt(8)
  v_lshl_or_b32 v8, v9, 16, v8
  s_waitcnt vmcnt(6)
  v_lshl_or_b32 v9, v11, 16, v10
  s_waitcnt vmcnt(4)
  v_lshl_or_b32 v10, v13, 16, v12
  s_waitcnt vmcnt(2)
  v_lshl_or_b32 v11, v15, 16, v14
  ds_write_b32 v3, v8 offset:0
  ds_write_b32 v3, v9 offset:1024
  ds_write_b32 v3, v10 offset:2048
  ds_write_b32 v3, v11 offset:3072
  s_waitcnt vmcnt(0)
  ds_write_b32 v3, v20 offset:4096
  v_lshlrev_b32 v3, 4, v2
  v_add_u32 v3, 146432, v3
  ds_write_b128 v3, v[16:19]
  v_mov_b32 v151, 32
  v_mov_b32 v152, 1
  s_cmp_lg_u32 s64, 0
  s_cbranch_scc1 L_g_26
  buffer_load_dword v150, v151, s[60:63], 0 offen sc1
L_g_26:
  s_waitcnt lgkmcnt(0)
  s_barrier
  v_lshrrev_b32 v30, 4, v1
  v_lshlrev_b32 v30, 3, v30
  v_bfe_u32 v31, v1, 2, 2
  v_add_u32 v30, v30, v31
  v_mul_u32_u24 v30, 144, v30
  v_and_b32 v31, 3, v1
  v_lshl_add_u32 v30, v31, 3, v30
  s_lshl_b32 s70, s64, 5
  s_add_u32 s70, s70, 131072
  v_add_u32 v30, s70, v30
  ds_read_b64_tr_b16 v[22:23], v30
  ds_read_b64_tr_b16 v[24:25], v30 offset:576
  ds_read_b64_tr_b16 v[26:27], v30 offset:4608
  ds_read_b64_tr_b16 v[28:29], v30 offset:5184
  v_and_b32 v31, 15, v1
  v_lshlrev_b32 v31, 12, v31
  v_lshrrev_b32 v30, 4, v1
  v_lshl_add_u32 v31, v30, 4, v31
  s_lshl_b32 s70, s65, 6
  s_lshl_b32 s71, s64, 4
  s_add_u32 s70, s70, s71
  s_lshl_b32 s70, s70, 12
  s_lshl_b32 s71, s66, 7
  s_add_u32 s70, s70, s71
  s_add_u32 s70, s70, 1048576
  s_waitcnt lgkmcnt(2)
  buffer_store_dwordx4 v[22:25], v31, s[52:55], s70 offen sc1
  s_waitcnt lgkmcnt(0)
  buffer_store_dwordx4 v[26:29], v31, s[52:55], s70 offen offset:64 sc1
  v_add_u32 v134, s94, v128
  v_add_u32 v135, s94, v129
  v_add_u32 v136, s94, v130
  v_add_u32 v137, s94, v131
  v_add_u32 v138, s94, v132
  v_add_u32 v139, s94, v133
  ds_read_b64_tr_b16 v[96:97], v138 offset:0
  ds_read_b64_tr_b16 v[98:99], v138 offset:1024
  ds_read_b128 v[104:107], v134 offset:0
  ds_read_b128 v[108:111], v134 offset:4096
  ds_read_b64_tr_b16 v[100:101], v139 offset:0
  ds_read_b64_tr_b16 v[102:103], v139 offset:1024
L_g1_27:
  s_waitcnt lgkmcnt(3)
  v_mfma_f32_32x32x16_bf16 v[32:47], v[96:99], v[104:107], v[32:47]
  ds_read_b64_tr_b16 v[112:113], v138 offset:4096
  ds_read_b64_tr_b16 v[114:115], v138 offset:5120
  ds_read_b128 v[120:123], v135 offset:0
  s_waitcnt lgkmcnt(5)
  v_mfma_f32_32x32x16_bf16 v[48:63], v[96:99], v[108:111], v[48:63]
  ds_read_b128 v[124:127], v135 offset:4096
  ds_read_b64_tr_b16 v[116:117], v139 offset:4096
  ds_read_b64_tr_b16 v[118:119], v139 offset:5120
  s_waitcnt lgkmcnt(6)
  v_mfma_f32_32x32x16_bf16 v[64:79], v[100:103], v[104:107], v[64:79]
  s_add_u32 s94, s94, 32768
  s_cmp_eq_u32 s94, 131072
  s_cselect_b32 s94, 0, s94
  v_mfma_f32_32x32x16_bf16 v[80:95], v[100:103], v[108:111], v[80:95]
  v_add_u32 v134, s94, v128
  v_add_u32 v135, s94, v129
  s_waitcnt lgkmcnt(3)
  v_mfma_f32_32x32x16_bf16 v[32:47], v[112:115], v[120:123], v[32:47]
  ds_read_b64_tr_b16 v[96:97], v138 offset:8192
  ds_read_b64_tr_b16 v[98:99], v138 offset:9216
  ds_read_b128 v[104:107], v136 offset:0
  s_waitcnt lgkmcnt(5)
  v_mfma_f32_32x32x16_bf16 v[48:63], v[112:115], v[124:127], v[48:63]
  ds_read_b128 v[108:111], v136 offset:4096
  ds_read_b64_tr_b16 v[100:101], v139 offset:8192
  ds_read_b64_tr_b16 v[102:103], v139 offset:9216
  s_waitcnt lgkmcnt(6)
  v_mfma_f32_32x32x16_bf16 v[64:79], v[116:119], v[120:123], v[64:79]
  v_add_u32 v136, s94, v130
  v_mfma_f32_32x32x16_bf16 v[80:95], v[116:119], v[124:127], v[80:95]
  s_waitcnt lgkmcnt(3)
  v_mfma_f32_32x32x16_bf16 v[32:47], v[96:99], v[104:107], v[32:47]
  ds_read_b64_tr_b16 v[112:113], v138 offset:12288
  ds_read_b64_tr_b16 v[114:115], v138 offset:13312
  ds_read_b128 v[120:123], v137 offset:0
  s_waitcnt lgkmcnt(5)
  v_mfma_f32_32x32x16_bf16 v[48:63], v[96:99], v[108:111], v[48:63]
  ds_read_b128 v[124:127], v137 offset:4096
  ds_read_b64_tr_b16 v[116:117], v139 offset:12288
  ds_read_b64_tr_b16 v[118:119], v139 offset:13312
  s_waitcnt lgkmcnt(6)
  v_mfma_f32_32x32x16_bf16 v[64:79], v[100:103], v[104:107], v[64:79]
  v_add_u32 v137, s94, v131
  v_add_u32 v138, s94, v132
  v_add_u32 v139, s94, v133
  v_mfma_f32_32x32x16_bf16 v[80:95], v[100:103], v[108:111], v[80:95]
  s_cmp_lg_u32 s92, 2
  s_cbranch_scc1 L_g_28
  s_waitcnt vmcnt(0)
L_g_28:
  s_waitcnt lgkmcnt(0)
  s_barrier
  v_mfma_f32_32x32x16_bf16 v[32:47], v[112:115], v[120:123], v[32:47]
  ds_read_b64_tr_b16 v[96:97], v138 offset:0
  ds_read_b64_tr_b16 v[98:99], v138 offset:1024
  ds_read_b128 v[104:107], v134 offset:0
  v_mfma_f32_32x32x16_bf16 v[48:63], v[112:115], v[124:127], v[48:63]
  ds_read_b128 v[108:111], v134 offset:4096
  ds_read_b64_tr_b16 v[100:101], v139 offset:0
  ds_read_b64_tr_b16 v[102:103], v139 offset:1024
  v_mfma_f32_32x32x16_bf16 v[64:79], v[116:119], v[120:123], v[64:79]
  s_lshl_b32 s82, s64, 4
  s_or_b32 s82, s82, s92
  s_cmp_lg_u32 s82, 2
  s_cbranch_scc1 L_g_29
  v_cmp_lt_u32 vcc, v150, v152
  s_cbranch_vccz L_pd_30
  s_mov_b32 s88, 0
L_pl_31:
  s_sleep 8
  buffer_load_dword v150, v151, s[60:63], 0 offen sc1
  s_waitcnt vmcnt(0)
  s_add_u32 s88, s88, 1
  s_cmp_gt_u32 s88, 0x20000
  s_cbranch_scc1 L_pd_30
  v_cmp_lt_u32 vcc, v150, v152
  s_cbranch_vccnz L_pl_31
L_pd_30:
  s_mov_b64 exec, 1
  s_lshl_b32 s78, s65, 7
  s_lshl_b32 s79, s66, 2
  s_add_u32 s78, s78, s79
  s_add_u32 s78, s78, 0
  v_mov_b32 v3, 1
  v_mov_b32 v4, s78
  buffer_store_dword v3, v4, s[52:55], 0 offen sc1
  s_mov_b64 exec, -1
L_g_29:
  v_mfma_f32_32x32x16_bf16 v[80:95], v[116:119], v[124:127], v[80:95]
  s_add_u32 s92, s92, 1
  s_cmp_lt_u32 s92, 7
  s_cbranch_scc1 L_g1_27
  s_waitcnt lgkmcnt(3)
  v_mfma_f32_32x32x16_bf16 v[32:47], v[96:99], v[104:107], v[32:47]
  ds_read_b64_tr_b16 v[112:113], v138 offset:4096
  ds_read_b64_tr_b16 v[114:115], v138 offset:5120
  ds_read_b128 v[120:123], v135 offset:0
  s_waitcnt lgkmcnt(5)
  v_mfma_f32_32x32x16_bf16 v[48:63], v[96:99], v[108:111], v[48:63]
  ds_read_b128 v[124:127], v135 offset:4096
  ds_read_b64_tr_b16 v[116:117], v139 offset:4096
  ds_read_b64_tr_b16 v[118:119], v139 offset:5120
  s_waitcnt lgkmcnt(6)
  v_mfma_f32_32x32x16_bf16 v[64:79], v[100:103], v[104:107], v[64:79]
  v_mfma_f32_32x32x16_bf16 v[80:95], v[100:103], v[108:111], v[80:95]
  s_waitcnt lgkmcnt(3)
  v_mfma_f32_32x32x16_bf16 v[32:47], v[112:115], v[120:123], v[32:47]
  ds_read_b64_tr_b16 v[96:97], v138 offset:8192
  ds_read_b64_tr_b16 v[98:99], v138 offset:9216
  ds_read_b128 v[104:107], v136 offset:0
  s_waitcnt lgkmcnt(5)
  v_mfma_f32_32x32x16_bf16 v[48:63], v[112:115], v[124:127], v[48:63]
  ds_read_b128 v[108:111], v136 offset:4096
  ds_read_b64_tr_b16 v[100:101], v139 offset:8192
  ds_read_b64_tr_b16 v[102:103], v139 offset:9216
  s_waitcnt lgkmcnt(6)
  v_mfma_f32_32x32x16_bf16 v[64:79], v[116:119], v[120:123], v[64:79]
  v_mfma_f32_32x32x16_bf16 v[80:95], v[116:119], v[124:127], v[80:95]
  s_waitcnt lgkmcnt(3)
  v_mfma_f32_32x32x16_bf16 v[32:47], v[96:99], v[104:107], v[32:47]
  ds_read_b64_tr_b16 v[112:113], v138 offset:12288
  ds_read_b64_tr_b16 v[114:115], v138 offset:13312
  ds_read_b128 v[120:123], v137 offset:0
  s_waitcnt lgkmcnt(5)
  v_mfma_f32_32x32x16_bf16 v[48:63], v[96:99], v[108:111], v[48:63]
  ds_read_b128 v[124:127], v137 offset:4096
  ds_read_b64_tr_b16 v[116:117], v139 offset:12288
  ds_read_b64_tr_b16 v[118:119], v139 offset:13312
  s_waitcnt lgkmcnt(6)
  v_mfma_f32_32x32x16_bf16 v[64:79], v[100:103], v[104:107], v[64:79]
  v_mfma_f32_32x32x16_bf16 v[80:95], v[100:103], v[108:111], v[80:95]
  s_waitcnt lgkmcnt(3)
  v_mfma_f32_32x32x16_bf16 v[32:47], v[112:115], v[120:123], v[32:47]
  s_waitcnt lgkmcnt(2)
  v_mfma_f32_32x32x16_bf16 v[48:63], v[112:115], v[124:127], v[48:63]
  s_waitcnt lgkmcnt(0)
  v_mfma_f32_32x32x16_bf16 v[64:79], v[116:119], v[120:123], v[64:79]
  v_mfma_f32_32x32x16_bf16 v[80:95], v[116:119], v[124:127], v[80:95]
  v_mov_b32 v3, 163432
  v_mov_b32 v4, 1
  s_mov_b64 exec, 1
  ds_add_u32 v3, v4
  s_mov_b64 exec, -1
  v_mov_b32 v151, 32
  v_mov_b32 v152, 1
  buffer_load_dword v150, v151, s[60:63], 0 offen sc1
  s_mov_b32 s76, 0x3fb8aa3b
  s_mov_b32 s77, 0x3fb8aa3b
  s_lshl_b32 s70, s67, 2
  s_and_b32 s71, s64, 2
  s_add_u32 s70, s70, s71
  s_mul_i32 s70, s70, 128
  s_lshl_b32 s71, s68, 3
  s_add_u32 s70, s70, s71
  s_and_b32 s71, s64, 1
  s_lshl_b32 s71, s71, 2
  s_add_u32 s70, s70, s71
  s_lshl_b32 s70, s70, 10
  s_add_u32 s70, s70, 8388608
  s_add_u32 s71, s70, 131072
  v_lshlrev_b32 v128, 4, v1
  v_pk_mul_f32 v[96:97], v[32:33], s[76:77]
  v_pk_mul_f32 v[98:99], v[34:35], s[76:77]
  v_pk_mul_f32 v[100:101], v[36:37], s[76:77]
  v_pk_mul_f32 v[102:103], v[38:39], s[76:77]
  v_exp_f32 v96, v96
  v_exp_f32 v97, v97
  v_exp_f32 v98, v98
  v_exp_f32 v99, v99
  v_exp_f32 v100, v100
  v_exp_f32 v101, v101
  v_exp_f32 v102, v102
  v_exp_f32 v103, v103
  v_pk_add_f32 v[96:97], v[96:97], 1.0 op_sel_hi:[1,0]
  v_pk_add_f32 v[98:99], v[98:99], 1.0 op_sel_hi:[1,0]
  v_pk_add_f32 v[100:101], v[100:101], 1.0 op_sel_hi:[1,0]
  v_pk_add_f32 v[102:103], v[102:103], 1.0 op_sel_hi:[1,0]
  v_pk_fma_f32 v[96:97], v[96:97], v[96:97], 1.0 op_sel_hi:[1,1,0]
  v_pk_fma_f32 v[98:99], v[98:99], v[98:99], 1.0 op_sel_hi:[1,1,0]
  v_pk_fma_f32 v[100:101], v[100:101], v[100:101], 1.0 op_sel_hi:[1,1,0]
  v_pk_fma_f32 v[102:103], v[102:103], v[102:103], 1.0 op_sel_hi:[1,1,0]
  v_rcp_f32 v96, v96
  v_rcp_f32 v97, v97
  v_rcp_f32 v98, v98
  v_rcp_f32 v99, v99
  v_rcp_f32 v100, v100
  v_rcp_f32 v101, v101
  v_rcp_f32 v102, v102
  v_rcp_f32 v103, v103
  v_pk_fma_f32 v[96:97], v[96:97], -2.0, 1.0 op_sel_hi:[1,0,0]
  v_pk_fma_f32 v[98:99], v[98:99], -2.0, 1.0 op_sel_hi:[1,0,0]
  v_pk_fma_f32 v[100:101], v[100:101], -2.0, 1.0 op_sel_hi:[1,0,0]
  v_pk_fma_f32 v[102:103], v[102:103], -2.0, 1.0 op_sel_hi:[1,0,0]
  v_pk_mul_f32 v[96:97], v[96:97], v[32:33]
  v_pk_mul_f32 v[98:99], v[98:99], v[34:35]
  v_pk_mul_f32 v[100:101], v[100:101], v[36:37]
  v_pk_mul_f32 v[102:103], v[102:103], v[38:39]
  v_cvt_pk_bf16_f32 v104, v96, v97
  v_cvt_pk_bf16_f32 v105, v98, v99
  v_cvt_pk_bf16_f32 v106, v100, v101
  v_cvt_pk_bf16_f32 v107, v102, v103
  v_pk_mul_f32 v[96:97], v[40:41], s[76:77]
  v_pk_mul_f32 v[98:99], v[42:43], s[76:77]
  v_pk_mul_f32 v[100:101], v[44:45], s[76:77]
  v_pk_mul_f32 v[102:103], v[46:47], s[76:77]
  v_exp_f32 v96, v96
  v_exp_f32 v97, v97
  v_exp_f32 v98, v98
  v_exp_f32 v99, v99
  v_exp_f32 v100, v100
  v_exp_f32 v101, v101
  v_exp_f32 v102, v102
  v_exp_f32 v103, v103
  v_pk_add_f32 v[96:97], v[96:97], 1.0 op_sel_hi:[1,0]
  v_pk_add_f32 v[98:99], v[98:99], 1.0 op_sel_hi:[1,0]
  v_pk_add_f32 v[100:101], v[100:101], 1.0 op_sel_hi:[1,0]
  v_pk_add_f32 v[102:103], v[102:103], 1.0 op_sel_hi:[1,0]
  v_pk_fma_f32 v[96:97], v[96:97], v[96:97], 1.0 op_sel_hi:[1,1,0]
  v_pk_fma_f32 v[98:99], v[98:99], v[98:99], 1.0 op_sel_hi:[1,1,0]
  v_pk_fma_f32 v[100:101], v[100:101], v[100:101], 1.0 op_sel_hi:[1,1,0]
  v_pk_fma_f32 v[102:103], v[102:103], v[102:103], 1.0 op_sel_hi:[1,1,0]
  v_rcp_f32 v96, v96
  v_rcp_f32 v97, v97
  v_rcp_f32 v98, v98
  v_rcp_f32 v99, v99
  v_rcp_f32 v100, v100
  v_rcp_f32 v101, v101
  v_rcp_f32 v102, v102
  v_rcp_f32 v103, v103
  v_pk_fma_f32 v[96:97], v[96:97], -2.0, 1.0 op_sel_hi:[1,0,0]
  v_pk_fma_f32 v[98:99], v[98:99], -2.0, 1.0 op_sel_hi:[1,0,0]
  v_pk_fma_f32 v[100:101], v[100:101], -2.0, 1.0 op_sel_hi:[1,0,0]
  v_pk_fma_f32 v[102:103], v[102:103], -2.0, 1.0 op_sel_hi:[1,0,0]
  v_pk_mul_f32 v[96:97], v[96:97], v[40:41]
  v_pk_mul_f32 v[98:99], v[98:99], v[42:43]
  v_pk_mul_f32 v[100:101], v[100:101], v[44:45]
  v_pk_mul_f32 v[102:103], v[102:103], v[46:47]
  v_cvt_pk_bf16_f32 v108, v96, v97
  v_cvt_pk_bf16_f32 v109, v98, v99
  v_cvt_pk_bf16_f32 v110, v100, v101
  v_cvt_pk_bf16_f32 v111, v102, v103
  v_pk_mul_f32 v[96:97], v[64:65], s[76:77]
  v_pk_mul_f32 v[98:99], v[66:67], s[76:77]
  v_pk_mul_f32 v[100:101], v[68:69], s[76:77]
  v_pk_mul_f32 v[102:103], v[70:71], s[76:77]
  v_exp_f32 v96, v96
  v_exp_f32 v97, v97
  v_exp_f32 v98, v98
  v_exp_f32 v99, v99
  v_exp_f32 v100, v100
  v_exp_f32 v101, v101
  v_exp_f32 v102, v102
  v_exp_f32 v103, v103
  v_pk_add_f32 v[96:97], v[96:97], 1.0 op_sel_hi:[1,0]
  v_pk_add_f32 v[98:99], v[98:99], 1.0 op_sel_hi:[1,0]
  v_pk_add_f32 v[100:101], v[100:101], 1.0 op_sel_hi:[1,0]
  v_pk_add_f32 v[102:103], v[102:103], 1.0 op_sel_hi:[1,0]
  v_pk_fma_f32 v[96:97], v[96:97], v[96:97], 1.0 op_sel_hi:[1,1,0]
  v_pk_fma_f32 v[98:99], v[98:99], v[98:99], 1.0 op_sel_hi:[1,1,0]
  v_pk_fma_f32 v[100:101], v[100:101], v[100:101], 1.0 op_sel_hi:[1,1,0]
  v_pk_fma_f32 v[102:103], v[102:103], v[102:103], 1.0 op_sel_hi:[1,1,0]
  v_rcp_f32 v96, v96
  v_rcp_f32 v97, v97
  v_rcp_f32 v98, v98
  v_rcp_f32 v99, v99
  v_rcp_f32 v100, v100
  v_rcp_f32 v101, v101
  v_rcp_f32 v102, v102
  v_rcp_f32 v103, v103
  v_pk_fma_f32 v[96:97], v[96:97], -2.0, 1.0 op_sel_hi:[1,0,0]
  v_pk_fma_f32 v[98:99], v[98:99], -2.0, 1.0 op_sel_hi:[1,0,0]
  v_pk_fma_f32 v[100:101], v[100:101], -2.0, 1.0 op_sel_hi:[1,0,0]
  v_pk_fma_f32 v[102:103], v[102:103], -2.0, 1.0 op_sel_hi:[1,0,0]
  v_pk_mul_f32 v[96:97], v[96:97], v[64:65]
  v_pk_mul_f32 v[98:99], v[98:99], v[66:67]
  v_pk_mul_f32 v[100:101], v[100:101], v[68:69]
  v_pk_mul_f32 v[102:103], v[102:103], v[70:71]
  v_cvt_pk_bf16_f32 v112, v96, v97
  v_cvt_pk_bf16_f32 v113, v98, v99
  v_cvt_pk_bf16_f32 v114, v100, v101
  v_cvt_pk_bf16_f32 v115, v102, v103
  v_pk_mul_f32 v[96:97], v[72:73], s[76:77]
  v_pk_mul_f32 v[98:99], v[74:75], s[76:77]
  v_pk_mul_f32 v[100:101], v[76:77], s[76:77]
  v_pk_mul_f32 v[102:103], v[78:79], s[76:77]
  v_exp_f32 v96, v96
  v_exp_f32 v97, v97
  v_exp_f32 v98, v98
  v_exp_f32 v99, v99
  v_exp_f32 v100, v100
  v_exp_f32 v101, v101
  v_exp_f32 v102, v102
  v_exp_f32 v103, v103
  v_pk_add_f32 v[96:97], v[96:97], 1.0 op_sel_hi:[1,0]
  v_pk_add_f32 v[98:99], v[98:99], 1.0 op_sel_hi:[1,0]
  v_pk_add_f32 v[100:101], v[100:101], 1.0 op_sel_hi:[1,0]
  v_pk_add_f32 v[102:103], v[102:103], 1.0 op_sel_hi:[1,0]
  v_pk_fma_f32 v[96:97], v[96:97], v[96:97], 1.0 op_sel_hi:[1,1,0]
  v_pk_fma_f32 v[98:99], v[98:99], v[98:99], 1.0 op_sel_hi:[1,1,0]
  v_pk_fma_f32 v[100:101], v[100:101], v[100:101], 1.0 op_sel_hi:[1,1,0]
  v_pk_fma_f32 v[102:103], v[102:103], v[102:103], 1.0 op_sel_hi:[1,1,0]
  v_rcp_f32 v96, v96
  v_rcp_f32 v97, v97
  v_rcp_f32 v98, v98
  v_rcp_f32 v99, v99
  v_rcp_f32 v100, v100
  v_rcp_f32 v101, v101
  v_rcp_f32 v102, v102
  v_rcp_f32 v103, v103
  v_pk_fma_f32 v[96:97], v[96:97], -2.0, 1.0 op_sel_hi:[1,0,0]
  v_pk_fma_f32 v[98:99], v[98:99], -2.0, 1.0 op_sel_hi:[1,0,0]
  v_pk_fma_f32 v[100:101], v[100:101], -2.0, 1.0 op_sel_hi:[1,0,0]
  v_pk_fma_f32 v[102:103], v[102:103], -2.0, 1.0 op_sel_hi:[1,0,0]
  v_pk_mul_f32 v[96:97], v[96:97], v[72:73]
  v_pk_mul_f32 v[98:99], v[98:99], v[74:75]
  v_pk_mul_f32 v[100:101], v[100:101], v[76:77]
  v_pk_mul_f32 v[102:103], v[102:103], v[78:79]
  v_cvt_pk_bf16_f32 v116, v96, v97
  v_cvt_pk_bf16_f32 v117, v98, v99
  v_cvt_pk_bf16_f32 v118, v100, v101
  v_cvt_pk_bf16_f32 v119, v102, v103
  buffer_store_dwordx4 v[104:107], v128, s[52:55], s70 offen offset:0 sc1
  buffer_store_dwordx4 v[108:111], v128, s[52:55], s70 offen offset:1024 sc1
  v_pk_mul_f32 v[96:97], v[48:49], s[76:77]
  v_pk_mul_f32 v[98:99], v[50:51], s[76:77]
  v_pk_mul_f32 v[100:101], v[52:53], s[76:77]
  v_pk_mul_f32 v[102:103], v[54:55], s[76:77]
  v_exp_f32 v96, v96
  v_exp_f32 v97, v97
  v_exp_f32 v98, v98
  v_exp_f32 v99, v99
  v_exp_f32 v100, v100
  v_exp_f32 v101, v101
  v_exp_f32 v102, v102
  v_exp_f32 v103, v103
  v_pk_add_f32 v[96:97], v[96:97], 1.0 op_sel_hi:[1,0]
  v_pk_add_f32 v[98:99], v[98:99], 1.0 op_sel_hi:[1,0]
  v_pk_add_f32 v[100:101], v[100:101], 1.0 op_sel_hi:[1,0]
  v_pk_add_f32 v[102:103], v[102:103], 1.0 op_sel_hi:[1,0]
  v_pk_fma_f32 v[96:97], v[96:97], v[96:97], 1.0 op_sel_hi:[1,1,0]
  v_pk_fma_f32 v[98:99], v[98:99], v[98:99], 1.0 op_sel_hi:[1,1,0]
  v_pk_fma_f32 v[100:101], v[100:101], v[100:101], 1.0 op_sel_hi:[1,1,0]
  v_pk_fma_f32 v[102:103], v[102:103], v[102:103], 1.0 op_sel_hi:[1,1,0]
  v_rcp_f32 v96, v96
  v_rcp_f32 v97, v97
  v_rcp_f32 v98, v98
  v_rcp_f32 v99, v99
  v_rcp_f32 v100, v100
  v_rcp_f32 v101, v101
  v_rcp_f32 v102, v102
  v_rcp_f32 v103, v103
  v_pk_fma_f32 v[96:97], v[96:97], -2.0, 1.0 op_sel_hi:[1,0,0]
  v_pk_fma_f32 v[98:99], v[98:99], -2.0, 1.0 op_sel_hi:[1,0,0]
  v_pk_fma_f32 v[100:101], v[100:101], -2.0, 1.0 op_sel_hi:[1,0,0]
  v_pk_fma_f32 v[102:103], v[102:103], -2.0, 1.0 op_sel_hi:[1,0,0]
  v_pk_mul_f32 v[96:97], v[96:97], v[48:49]
  v_pk_mul_f32 v[98:99], v[98:99], v[50:51]
  v_pk_mul_f32 v[100:101], v[100:101], v[52:53]
  v_pk_mul_f32 v[102:103], v[102:103], v[54:55]
  v_cvt_pk_bf16_f32 v120, v96, v97
  v_cvt_pk_bf16_f32 v121, v98, v99
  v_cvt_pk_bf16_f32 v122, v100, v101
  v_cvt_pk_bf16_f32 v123, v102, v103
  buffer_store_dwordx4 v[112:115], v128, s[52:55], s70 offen offset:2048 sc1
  buffer_store_dwordx4 v[116:119], v128, s[52:55], s70 offen offset:3072 sc1
  v_pk_mul_f32 v[96:97], v[56:57], s[76:77]
  v_pk_mul_f32 v[98:99], v[58:59], s[76:77]
  v_pk_mul_f32 v[100:101], v[60:61], s[76:77]
  v_pk_mul_f32 v[102:103], v[62:63], s[76:77]
  v_exp_f32 v96, v96
  v_exp_f32 v97, v97
  v_exp_f32 v98, v98
  v_exp_f32 v99, v99
  v_exp_f32 v100, v100
  v_exp_f32 v101, v101
  v_exp_f32 v102, v102
  v_exp_f32 v103, v103
  v_pk_add_f32 v[96:97], v[96:97], 1.0 op_sel_hi:[1,0]
  v_pk_add_f32 v[98:99], v[98:99], 1.0 op_sel_hi:[1,0]
  v_pk_add_f32 v[100:101], v[100:101], 1.0 op_sel_hi:[1,0]
  v_pk_add_f32 v[102:103], v[102:103], 1.0 op_sel_hi:[1,0]
  v_pk_fma_f32 v[96:97], v[96:97], v[96:97], 1.0 op_sel_hi:[1,1,0]
  v_pk_fma_f32 v[98:99], v[98:99], v[98:99], 1.0 op_sel_hi:[1,1,0]
  v_pk_fma_f32 v[100:101], v[100:101], v[100:101], 1.0 op_sel_hi:[1,1,0]
  v_pk_fma_f32 v[102:103], v[102:103], v[102:103], 1.0 op_sel_hi:[1,1,0]
  v_rcp_f32 v96, v96
  v_rcp_f32 v97, v97
  v_rcp_f32 v98, v98
  v_rcp_f32 v99, v99
  v_rcp_f32 v100, v100
  v_rcp_f32 v101, v101
  v_rcp_f32 v102, v102
  v_rcp_f32 v103, v103
  v_pk_fma_f32 v[96:97], v[96:97], -2.0, 1.0 op_sel_hi:[1,0,0]
  v_pk_fma_f32 v[98:99], v[98:99], -2.0, 1.0 op_sel_hi:[1,0,0]
  v_pk_fma_f32 v[100:101], v[100:101], -2.0, 1.0 op_sel_hi:[1,0,0]
  v_pk_fma_f32 v[102:103], v[102:103], -2.0, 1.0 op_sel_hi:[1,0,0]
  v_pk_mul_f32 v[96:97], v[96:97], v[56:57]
  v_pk_mul_f32 v[98:99], v[98:99], v[58:59]
  v_pk_mul_f32 v[100:101], v[100:101], v[60:61]
  v_pk_mul_f32 v[102:103], v[102:103], v[62:63]
  v_cvt_pk_bf16_f32 v124, v96, v97
  v_cvt_pk_bf16_f32 v125, v98, v99
  v_cvt_pk_bf16_f32 v126, v100, v101
  v_cvt_pk_bf16_f32 v127, v102, v103
  buffer_store_dwordx4 v[120:123], v128, s[52:55], s71 offen offset:0 sc1
  buffer_store_dwordx4 v[124:127], v128, s[52:55], s71 offen offset:1024 sc1
  v_pk_mul_f32 v[96:97], v[80:81], s[76:77]
  v_pk_mul_f32 v[98:99], v[82:83], s[76:77]
  v_pk_mul_f32 v[100:101], v[84:85], s[76:77]
  v_pk_mul_f32 v[102:103], v[86:87], s[76:77]
  v_exp_f32 v96, v96
  v_exp_f32 v97, v97
  v_exp_f32 v98, v98
  v_exp_f32 v99, v99
  v_exp_f32 v100, v100
  v_exp_f32 v101, v101
  v_exp_f32 v102, v102
  v_exp_f32 v103, v103
  v_pk_add_f32 v[96:97], v[96:97], 1.0 op_sel_hi:[1,0]
  v_pk_add_f32 v[98:99], v[98:99], 1.0 op_sel_hi:[1,0]
  v_pk_add_f32 v[100:101], v[100:101], 1.0 op_sel_hi:[1,0]
  v_pk_add_f32 v[102:103], v[102:103], 1.0 op_sel_hi:[1,0]
  v_pk_fma_f32 v[96:97], v[96:97], v[96:97], 1.0 op_sel_hi:[1,1,0]
  v_pk_fma_f32 v[98:99], v[98:99], v[98:99], 1.0 op_sel_hi:[1,1,0]
  v_pk_fma_f32 v[100:101], v[100:101], v[100:101], 1.0 op_sel_hi:[1,1,0]
  v_pk_fma_f32 v[102:103], v[102:103], v[102:103], 1.0 op_sel_hi:[1,1,0]
  v_rcp_f32 v96, v96
  v_rcp_f32 v97, v97
  v_rcp_f32 v98, v98
  v_rcp_f32 v99, v99
  v_rcp_f32 v100, v100
  v_rcp_f32 v101, v101
  v_rcp_f32 v102, v102
  v_rcp_f32 v103, v103
  v_pk_fma_f32 v[96:97], v[96:97], -2.0, 1.0 op_sel_hi:[1,0,0]
  v_pk_fma_f32 v[98:99], v[98:99], -2.0, 1.0 op_sel_hi:[1,0,0]
  v_pk_fma_f32 v[100:101], v[100:101], -2.0, 1.0 op_sel_hi:[1,0,0]
  v_pk_fma_f32 v[102:103], v[102:103], -2.0, 1.0 op_sel_hi:[1,0,0]
  v_pk_mul_f32 v[96:97], v[96:97], v[80:81]
  v_pk_mul_f32 v[98:99], v[98:99], v[82:83]
  v_pk_mul_f32 v[100:101], v[100:101], v[84:85]
  v_pk_mul_f32 v[102:103], v[102:103], v[86:87]
  v_cvt_pk_bf16_f32 v104, v96, v97
  v_cvt_pk_bf16_f32 v105, v98, v99
  v_cvt_pk_bf16_f32 v106, v100, v101
  v_cvt_pk_bf16_f32 v107, v102, v103
  buffer_store_dwordx4 v[104:107], v128, s[52:55], s71 offen offset:2048 sc1
  v_pk_mul_f32 v[96:97], v[88:89], s[76:77]
  v_pk_mul_f32 v[98:99], v[90:91], s[76:77]
  v_pk_mul_f32 v[100:101], v[92:93], s[76:77]
  v_pk_mul_f32 v[102:103], v[94:95], s[76:77]
  v_exp_f32 v96, v96
  v_exp_f32 v97, v97
  v_exp_f32 v98, v98
  v_exp_f32 v99, v99
  v_exp_f32 v100, v100
  v_exp_f32 v101, v101
  v_exp_f32 v102, v102
  v_exp_f32 v103, v103
  v_pk_add_f32 v[96:97], v[96:97], 1.0 op_sel_hi:[1,0]
  v_pk_add_f32 v[98:99], v[98:99], 1.0 op_sel_hi:[1,0]
  v_pk_add_f32 v[100:101], v[100:101], 1.0 op_sel_hi:[1,0]
  v_pk_add_f32 v[102:103], v[102:103], 1.0 op_sel_hi:[1,0]
  v_pk_fma_f32 v[96:97], v[96:97], v[96:97], 1.0 op_sel_hi:[1,1,0]
  v_pk_fma_f32 v[98:99], v[98:99], v[98:99], 1.0 op_sel_hi:[1,1,0]
  v_pk_fma_f32 v[100:101], v[100:101], v[100:101], 1.0 op_sel_hi:[1,1,0]
  v_pk_fma_f32 v[102:103], v[102:103], v[102:103], 1.0 op_sel_hi:[1,1,0]
  v_rcp_f32 v96, v96
  v_rcp_f32 v97, v97
  v_rcp_f32 v98, v98
  v_rcp_f32 v99, v99
  v_rcp_f32 v100, v100
  v_rcp_f32 v101, v101
  v_rcp_f32 v102, v102
  v_rcp_f32 v103, v103
  v_pk_fma_f32 v[96:97], v[96:97], -2.0, 1.0 op_sel_hi:[1,0,0]
  v_pk_fma_f32 v[98:99], v[98:99], -2.0, 1.0 op_sel_hi:[1,0,0]
  v_pk_fma_f32 v[100:101], v[100:101], -2.0, 1.0 op_sel_hi:[1,0,0]
  v_pk_fma_f32 v[102:103], v[102:103], -2.0, 1.0 op_sel_hi:[1,0,0]
  v_pk_mul_f32 v[96:97], v[96:97], v[88:89]
  v_pk_mul_f32 v[98:99], v[98:99], v[90:91]
  v_pk_mul_f32 v[100:101], v[100:101], v[92:93]
  v_pk_mul_f32 v[102:103], v[102:103], v[94:95]
  v_cvt_pk_bf16_f32 v108, v96, v97
  v_cvt_pk_bf16_f32 v109, v98, v99
  v_cvt_pk_bf16_f32 v110, v100, v101
  v_cvt_pk_bf16_f32 v111, v102, v103
  buffer_store_dwordx4 v[108:111], v128, s[52:55], s71 offen offset:3072 sc1
  s_setprio 0
  v_mov_b32 v3, 163432
  s_waitcnt lgkmcnt(0)
  s_mov_b32 s88, 0
L_lw_32:
  ds_read_b32 v4, v3
  s_waitcnt lgkmcnt(0)
  v_readfirstlane_b32 s82, v4
  s_nop 0
  s_cmp_ge_u32 s82, 4
  s_cbranch_scc1 L_ld_33
  s_sleep 1
  s_add_u32 s88, s88, 1
  s_cmp_gt_u32 s88, 0x100000
  s_cbranch_scc0 L_lw_32
L_ld_33:
  s_add_u32 m0, s89, 0
  s_lshl_b32 s87, s4, 4
  buffer_load_dwordx4 v144, s[48:51], s87 offen offset:0 lds
  buffer_load_dwordx4 v145, s[48:51], s87 offen offset:1024 lds
  s_add_u32 m0, s89, 2048
  s_lshl_b32 s87, s5, 4
  buffer_load_dwordx4 v144, s[48:51], s87 offen offset:0 lds
  buffer_load_dwordx4 v145, s[48:51], s87 offen offset:1024 lds
  s_add_u32 m0, s89, 4096
  s_lshl_b32 s87, s6, 4
  buffer_load_dwordx4 v144, s[48:51], s87 offen offset:0 lds
  buffer_load_dwordx4 v145, s[48:51], s87 offen offset:1024 lds
  s_add_u32 m0, s89, 6144
  s_lshl_b32 s87, s7, 4
  buffer_load_dwordx4 v144, s[48:51], s87 offen offset:0 lds
  buffer_load_dwordx4 v145, s[48:51], s87 offen offset:1024 lds
  s_waitcnt vmcnt(8)
  v_cmp_lt_u32 vcc, v150, v152
  s_cbranch_vccz L_pd_34
  s_mov_b32 s88, 0
L_pl_35:
  s_sleep 8
  buffer_load_dword v150, v151, s[60:63], 0 offen sc1
  s_waitcnt vmcnt(0)
  s_add_u32 s88, s88, 1
  s_cmp_gt_u32 s88, 0x20000
  s_cbranch_scc1 L_pd_34
  v_cmp_lt_u32 vcc, v150, v152
  s_cbranch_vccnz L_pl_35
L_pd_34:
  s_mov_b64 exec, 1
  s_lshl_b32 s78, s67, 1
  s_lshr_b32 s79, s64, 1
  s_add_u32 s78, s78, s79
  s_lshl_b32 s78, s78, 7
  s_lshl_b32 s79, s68, 1
  s_add_u32 s78, s78, 1024
  s_lshl_b32 s79, s79, 2
  s_add_u32 s78, s78, s79
  s_and_b32 s79, s64, 1
  s_lshl_b32 s79, s79, 2
  s_add_u32 s78, s78, s79
  v_mov_b32 v3, 1
  v_mov_b32 v4, s78
  buffer_store_dword v3, v4, s[52:55], 0 offen sc1
  s_mov_b64 exec, -1
  s_branch L_join
L_spare:
  v_lshrrev_b32 v30, 3, v1
  v_lshlrev_b32 v30, 10, v30
  v_and_b32 v31, 7, v1
  v_lshl_add_u32 v30, v31, 4, v30
  s_lshl_b32 s70, s66, 6
  s_lshl_b32 s71, s64, 4
  s_add_u32 s70, s70, s71
  s_lshl_b32 s70, s70, 10
  s_lshl_b32 s71, s65, 7
  s_add_u32 s70, s70, s71
  s_add_u32 s71, s70, 8192
  buffer_load_dwordx4 v[22:25], v30, s[40:43], s70 offen
  buffer_load_dwordx4 v[26:29], v30, s[40:43], s71 offen
  s_lshl_b32 s70, s2, 2
  s_add_u32 s70, s70, s64
  s_lshl_b32 s70, s70, 7
  v_lshl_add_u32 v21, v1, 1, s70
  global_load_ushort v8, v21, s[6:7]
  global_load_ushort v9, v21, s[8:9]
  global_load_ushort v10, v21, s[10:11]
  global_load_ushort v11, v21, s[12:13]
  global_load_ushort v12, v21, s[14:15]
  global_load_ushort v13, v21, s[16:17]
  s_lshr_b32 s70, s64, 1
  s_lshl_b32 s71, s2, 1
  s_add_u32 s70, s70, s71
  s_lshl_b32 s70, s70, 1
  v_mov_b32 v21, s70
  global_load_ushort v14, v21, s[18:19]
  global_load_ushort v15, v21, s[20:21]
  s_getpc_b64 s[72:73]
L_pc_36:
  s_add_u32 s72, s72, L_gtab-L_pc_36
  s_addc_u32 s73, s73, 0
  v_lshlrev_b32 v21, 4, v2
  global_load_dwordx4 v[16:19], v21, s[72:73]
  global_load_ushort v20, v21, s[72:73] offset:16
  s_cmp_lg_u32 s64, 0
  s_cbranch_scc1 L_g_37
  s_getpc_b64 s[72:73]
L_cp_38:
  s_sub_u32 s72, s72, L_cp_38-gated_mix__ssm_conv_s4__dense_activation_mish__prompt_kernel
  s_subb_u32 s73, s73, 0
  v_lshlrev_b32 v3, 7, v1
  v_min_u32 v124, L_gtab-gated_mix__ssm_conv_s4__dense_activation_mish__prompt_kernel-4, v3
  global_load_dword v120, v124, s[72:73]
  v_add_u32 v3, 8192, v3
  v_min_u32 v124, L_gtab-gated_mix__ssm_conv_s4__dense_activation_mish__prompt_kernel-4, v3
  global_load_dword v121, v124, s[72:73]
  v_add_u32 v3, 8192, v3
  v_min_u32 v124, L_gtab-gated_mix__ssm_conv_s4__dense_activation_mish__prompt_kernel-4, v3
  global_load_dword v122, v124, s[72:73]
  v_add_u32 v3, 8192, v3
  v_min_u32 v124, L_gtab-gated_mix__ssm_conv_s4__dense_activation_mish__prompt_kernel-4, v3
  global_load_dword v123, v124, s[72:73]
  v_add_u32 v3, 8192, v3
L_g_37:
  s_cmp_lg_u32 s64, 1
  s_cbranch_scc1 L_g_39
  v_and_b32 v3, 3, v1
  v_lshlrev_b32 v3, 21, v3
  v_add_u32 v3, 10485632, v3
  v_mov_b32 v4, 0x400000
  v_cmp_eq_u32 vcc, 4, v1
  s_nop 1
  v_cndmask_b32 v3, v3, v4, vcc
  v_mov_b32 v4, 0x780000
  v_cmp_eq_u32 vcc, 5, v1
  s_nop 1
  v_cndmask_b32 v3, v3, v4, vcc
  buffer_load_dword v125, v3, s[52:55], 0 offen
  v_mov_b32 v3, 0
  buffer_load_dword v126, v3, s[56:59], 0 offen
  buffer_load_dword v127, v3, s[48:51], 0 offen
L_g_39:
  s_lshl_b32 s70, s65, 2
  s_add_u32 s70, s70, s66
  s_sub_u32 s70, s70, 28
  s_lshl_b32 s71, s70, 6
  s_lshl_b32 s72, s64, 4
  s_add_u32 s86, s71, s72
  s_lshl_b32 s72, s86, 10
  v_lshlrev_b32 v128, 4, v1
  v_add_u32 v129, 4096, v128
  v_add_u32 v130, 8192, v128
  v_add_u32 v131, 12288, v128
  global_load_dwordx4 v[96:99], v128, s[30:31]
  buffer_load_dwordx4 v[32:35], v128, s[40:43], s72 offen offset:0
  buffer_load_dwordx4 v[36:39], v128, s[40:43], s72 offen offset:1024
  buffer_load_dwordx4 v[40:43], v128, s[40:43], s72 offen offset:2048
  buffer_load_dwordx4 v[44:47], v128, s[40:43], s72 offen offset:3072
  buffer_load_dwordx4 v[48:51], v129, s[40:43], s72 offen offset:0
  buffer_load_dwordx4 v[52:55], v129, s[40:43], s72 offen offset:1024
  buffer_load_dwordx4 v[56:59], v129, s[40:43], s72 offen offset:2048
  buffer_load_dwordx4 v[60:63], v129, s[40:43], s72 offen offset:3072
  buffer_load_dwordx4 v[64:67], v130, s[40:43], s72 offen offset:0
  buffer_load_dwordx4 v[68:71], v130, s[40:43], s72 offen offset:1024
  buffer_load_dwordx4 v[72:75], v130, s[40:43], s72 offen offset:2048
  buffer_load_dwordx4 v[76:79], v130, s[40:43], s72 offen offset:3072
  buffer_load_dwordx4 v[80:83], v131, s[40:43], s72 offen offset:0
  buffer_load_dwordx4 v[84:87], v131, s[40:43], s72 offen offset:1024
  buffer_load_dwordx4 v[88:91], v131, s[40:43], s72 offen offset:2048
  buffer_load_dwordx4 v[92:95], v131, s[40:43], s72 offen offset:3072
  v_lshrrev_b32 v30, 3, v1
  v_mul_u32_u24 v30, 144, v30
  v_and_b32 v31, 7, v1
  v_lshl_add_u32 v30, v31, 4, v30
  s_mul_i32 s70, s64, 2304
  s_add_u32 s70, s70, 131072
  v_add_u32 v30, s70, v30
  s_waitcnt vmcnt(28)
  ds_write_b128 v30, v[22:25]
  s_waitcnt vmcnt(27)
  ds_write_b128 v30, v[26:29] offset:1152
  v_lshlrev_b32 v3, 2, v2
  v_add_u32 v3, 141312, v3
  s_waitcnt vmcnt(25)
  v_lshl_or_b32 v8, v9, 16, v8
  s_waitcnt vmcnt(23)
  v_lshl_or_b32 v9, v11, 16, v10
  s_waitcnt vmcnt(21)
  v_lshl_or_b32 v10, v13, 16, v12
  s_waitcnt vmcnt(19)
  v_lshl_or_b32 v11, v15, 16, v14
  ds_write_b32 v3, v8 offset:0
  ds_write_b32 v3, v9 offset:1024
  ds_write_b32 v3, v10 offset:2048
  ds_write_b32 v3, v11 offset:3072
  s_waitcnt vmcnt(17)
  ds_write_b32 v3, v20 offset:4096
  v_lshlrev_b32 v3, 4, v2
  v_add_u32 v3, 146432, v3
  ds_write_b128 v3, v[16:19]
  v_mov_b32 v151, 32
  v_mov_b32 v152, 1
  s_cmp_lg_u32 s64, 0
  s_cbranch_scc1 L_g_40
  buffer_load_dword v150, v151, s[60:63], 0 offen sc1
L_g_40:
  s_waitcnt lgkmcnt(0)
  s_barrier
  v_lshrrev_b32 v30, 4, v1
  v_lshlrev_b32 v30, 3, v30
  v_bfe_u32 v31, v1, 2, 2
  v_add_u32 v30, v30, v31
  v_mul_u32_u24 v30, 144, v30
  v_and_b32 v31, 3, v1
  v_lshl_add_u32 v30, v31, 3, v30
  s_lshl_b32 s70, s64, 5
  s_add_u32 s70, s70, 131072
  v_add_u32 v30, s70, v30
  ds_read_b64_tr_b16 v[22:23], v30
  ds_read_b64_tr_b16 v[24:25], v30 offset:576
  ds_read_b64_tr_b16 v[26:27], v30 offset:4608
  ds_read_b64_tr_b16 v[28:29], v30 offset:5184
  v_and_b32 v31, 15, v1
  v_lshlrev_b32 v31, 12, v31
  v_lshrrev_b32 v30, 4, v1
  v_lshl_add_u32 v31, v30, 4, v31
  s_lshl_b32 s70, s65, 6
  s_lshl_b32 s71, s64, 4
  s_add_u32 s70, s70, s71
  s_lshl_b32 s70, s70, 12
  s_lshl_b32 s71, s66, 7
  s_add_u32 s70, s70, s71
  s_add_u32 s70, s70, 1048576
  s_waitcnt lgkmcnt(2)
  buffer_store_dwordx4 v[22:25], v31, s[52:55], s70 offen sc1
  s_waitcnt lgkmcnt(0)
  buffer_store_dwordx4 v[26:29], v31, s[52:55], s70 offen offset:64 sc1
  s_waitcnt vmcnt(0)
  s_barrier
  s_cmp_lg_u32 s64, 0
  s_cbranch_scc1 L_g_41
  v_cmp_lt_u32 vcc, v150, v152
  s_cbranch_vccz L_pd_42
  s_mov_b32 s88, 0
L_pl_43:
  s_sleep 8
  buffer_load_dword v150, v151, s[60:63], 0 offen sc1
  s_waitcnt vmcnt(0)
  s_add_u32 s88, s88, 1
  s_cmp_gt_u32 s88, 0x20000
  s_cbranch_scc1 L_pd_42
  v_cmp_lt_u32 vcc, v150, v152
  s_cbranch_vccnz L_pl_43
L_pd_42:
  s_mov_b64 exec, 1
  s_lshl_b32 s78, s65, 7
  s_lshl_b32 s79, s66, 2
  s_add_u32 s78, s78, s79
  s_add_u32 s78, s78, 0
  v_mov_b32 v3, 1
  v_mov_b32 v4, s78
  buffer_store_dword v3, v4, s[52:55], 0 offen sc1
  s_mov_b64 exec, -1
L_g_41:
  s_barrier
  s_barrier
  s_barrier
  s_barrier
  s_barrier
  s_barrier
  v_mov_b32 v3, 163432
  v_mov_b32 v4, 1
  s_mov_b64 exec, 1
  ds_add_u32 v3, v4
  s_mov_b64 exec, -1
  s_setprio 0
  s_lshr_b32 s70, s66, 3
  s_lshl_b32 s95, s65, 2
  s_add_u32 s95, s95, s70
  s_and_b32 s96, s66, 7
  s_mul_i32 s70, s64, 458752
  s_lshl_b32 s71, s96, 7
  s_add_u32 s97, s70, s71
  s_lshr_b32 s70, s64, 1
  s_lshl_b32 s71, s95, 1
  s_add_u32 s72, s71, s70
  s_xor_b32 s70, s70, 1
  s_add_u32 s73, s71, s70
  s_mul_i32 s70, s64, 28
  s_mul_i32 s72, s72, 128
  s_mul_i32 s73, s73, 128
  s_add_u32 s72, s72, s70
  s_add_u32 s73, s73, s70
  s_lshl_b32 s72, s72, 10
  s_lshl_b32 s73, s73, 10
  s_add_u32 s98, s72, 8388608
  s_add_u32 s99, s73, 8388608
  s_mul_i32 s70, s96, 7
  s_lshr_b32 s70, s70, 1
  s_and_b32 s71, s95, 3
  s_mul_i32 s71, s71, 7
  s_add_u32 s70, s70, s71
  s_cmp_ge_u32 s70, 28
  s_cselect_b32 s71, 28, 0
  s_sub_u32 s70, s70, s71
  s_lshl_b32 s70, s70, 10
  s_mov_b32 s4, s70
  s_add_u32 s70, s70, 1024
  s_cmp_eq_u32 s70, 28672
  s_cselect_b32 s70, 0, s70
  s_mov_b32 s5, s70
  s_add_u32 s70, s70, 1024
  s_cmp_eq_u32 s70, 28672
  s_cselect_b32 s70, 0, s70
  s_mov_b32 s6, s70
  s_add_u32 s70, s70, 1024
  s_cmp_eq_u32 s70, 28672
  s_cselect_b32 s70, 0, s70
  s_mov_b32 s7, s70
  s_add_u32 s70, s70, 1024
  s_cmp_eq_u32 s70, 28672
  s_cselect_b32 s70, 0, s70
  s_mov_b32 s8, s70
  s_add_u32 s70, s70, 1024
  s_cmp_eq_u32 s70, 28672
  s_cselect_b32 s70, 0, s70
  s_mov_b32 s9, s70
  s_add_u32 s70, s70, 1024
  s_cmp_eq_u32 s70, 28672
  s_cselect_b32 s70, 0, s70
  s_mov_b32 s10, s70
  s_add_u32 s70, s70, 1024
  s_cmp_eq_u32 s70, 28672
  s_cselect_b32 s70, 0, s70
  s_mov_b32 s11, s70
  s_add_u32 s70, s70, 1024
  s_cmp_eq_u32 s70, 28672
  s_cselect_b32 s70, 0, s70
  s_mov_b32 s12, s70
  s_add_u32 s70, s70, 1024
  s_cmp_eq_u32 s70, 28672
  s_cselect_b32 s70, 0, s70
  s_mov_b32 s13, s70
  s_add_u32 s70, s70, 1024
  s_cmp_eq_u32 s70, 28672
  s_cselect_b32 s70, 0, s70
  s_mov_b32 s14, s70
  s_add_u32 s70, s70, 1024
  s_cmp_eq_u32 s70, 28672
  s_cselect_b32 s70, 0, s70
  s_mov_b32 s15, s70
  s_add_u32 s70, s70, 1024
  s_cmp_eq_u32 s70, 28672
  s_cselect_b32 s70, 0, s70
  s_mov_b32 s16, s70
  s_add_u32 s70, s70, 1024
  s_cmp_eq_u32 s70, 28672
  s_cselect_b32 s70, 0, s70
  s_mov_b32 s17, s70
  s_add_u32 s70, s70, 1024
  s_cmp_eq_u32 s70, 28672
  s_cselect_b32 s70, 0, s70
  s_mov_b32 s18, s70
  s_add_u32 s70, s70, 1024
  s_cmp_eq_u32 s70, 28672
  s_cselect_b32 s70, 0, s70
  s_mov_b32 s19, s70
  s_add_u32 s70, s70, 1024
  s_cmp_eq_u32 s70, 28672
  s_cselect_b32 s70, 0, s70
  s_mov_b32 s20, s70
  s_add_u32 s70, s70, 1024
  s_cmp_eq_u32 s70, 28672
  s_cselect_b32 s70, 0, s70
  s_mov_b32 s21, s70
  s_add_u32 s70, s70, 1024
  s_cmp_eq_u32 s70, 28672
  s_cselect_b32 s70, 0, s70
  s_mov_b32 s22, s70
  s_add_u32 s70, s70, 1024
  s_cmp_eq_u32 s70, 28672
  s_cselect_b32 s70, 0, s70
  s_mov_b32 s23, s70
  s_add_u32 s70, s70, 1024
  s_cmp_eq_u32 s70, 28672
  s_cselect_b32 s70, 0, s70
  s_mov_b32 s24, s70
  s_add_u32 s70, s70, 1024
  s_cmp_eq_u32 s70, 28672
  s_cselect_b32 s70, 0, s70
  s_mov_b32 s25, s70
  s_add_u32 s70, s70, 1024
  s_cmp_eq_u32 s70, 28672
  s_cselect_b32 s70, 0, s70
  s_mov_b32 s26, s70
  s_add_u32 s70, s70, 1024
  s_cmp_eq_u32 s70, 28672
  s_cselect_b32 s70, 0, s70
  s_mov_b32 s27, s70
  s_add_u32 s70, s70, 1024
  s_cmp_eq_u32 s70, 28672
  s_cselect_b32 s70, 0, s70
  s_mov_b32 s28, s70
  s_add_u32 s70, s70, 1024
  s_cmp_eq_u32 s70, 28672
  s_cselect_b32 s70, 0, s70
  s_mov_b32 s29, s70
  s_add_u32 s70, s70, 1024
  s_cmp_eq_u32 s70, 28672
  s_cselect_b32 s70, 0, s70
  s_mov_b32 s30, s70
  s_add_u32 s70, s70, 1024
  s_cmp_eq_u32 s70, 28672
  s_cselect_b32 s70, 0, s70
  s_mov_b32 s31, s70
  s_add_u32 s70, s70, 1024
  s_cmp_eq_u32 s70, 28672
  s_cselect_b32 s70, 0, s70
  v_lshrrev_b32 v4, 3, v1
  v_bfe_u32 v5, v1, 4, 1
  v_lshlrev_b32 v5, 2, v5
  v_and_b32 v6, 7, v1
  v_xor_b32 v5, v5, v6
  v_lshlrev_b32 v4, 10, v4
  v_lshl_add_u32 v144, v5, 4, v4
  v_add_u32 v144, s97, v144
  v_add_u32 v145, 7168, v144
  s_mul_i32 s89, s64, 24576
  v_lshlrev_b32 v147, 4, v1
  v_add_u32 v146, s98, v147
  v_add_u32 v147, s99, v147
  v_bfe_u32 v4, v1, 2, 2
  v_lshrrev_b32 v5, 5, v1
  v_lshl_add_u32 v5, v5, 2, v4
  v_lshlrev_b32 v5, 7, v5
  v_lshrrev_b32 v4, 1, v4
  s_and_b32 s70, s64, 1
  v_xor_b32 v4, s70, v4
  v_lshl_add_u32 v5, v4, 6, v5
  v_bfe_u32 v4, v1, 4, 1
  v_lshl_add_u32 v5, v4, 5, v5
  v_and_b32 v4, 3, v1
  v_lshl_add_u32 v5, v4, 3, v5
  v_add_u32 v148, s89, v5
  v_xor_b32 v149, 64, v148
  v_dot2_f32_bf16 v100, v32, v96, 0
  v_dot2_f32_bf16 v101, v36, v96, 0
  v_dot2_f32_bf16 v102, v40, v96, 0
  v_dot2_f32_bf16 v103, v44, v96, 0
  v_dot2_f32_bf16 v104, v48, v96, 0
  v_dot2_f32_bf16 v105, v52, v96, 0
  v_dot2_f32_bf16 v106, v56, v96, 0
  v_dot2_f32_bf16 v107, v60, v96, 0
  v_dot2_f32_bf16 v108, v64, v96, 0
  v_dot2_f32_bf16 v109, v68, v96, 0
  v_dot2_f32_bf16 v110, v72, v96, 0
  v_dot2_f32_bf16 v111, v76, v96, 0
  v_dot2_f32_bf16 v112, v80, v96, 0
  v_dot2_f32_bf16 v113, v84, v96, 0
  v_dot2_f32_bf16 v114, v88, v96, 0
  v_dot2_f32_bf16 v115, v92, v96, 0
  v_dot2_f32_bf16 v100, v33, v97, v100
  v_dot2_f32_bf16 v101, v37, v97, v101
  v_dot2_f32_bf16 v102, v41, v97, v102
  v_dot2_f32_bf16 v103, v45, v97, v103
  v_dot2_f32_bf16 v104, v49, v97, v104
  v_dot2_f32_bf16 v105, v53, v97, v105
  v_dot2_f32_bf16 v106, v57, v97, v106
  v_dot2_f32_bf16 v107, v61, v97, v107
  v_dot2_f32_bf16 v108, v65, v97, v108
  v_dot2_f32_bf16 v109, v69, v97, v109
  v_dot2_f32_bf16 v110, v73, v97, v110
  v_dot2_f32_bf16 v111, v77, v97, v111
  v_dot2_f32_bf16 v112, v81, v97, v112
  v_dot2_f32_bf16 v113, v85, v97, v113
  v_dot2_f32_bf16 v114, v89, v97, v114
  v_dot2_f32_bf16 v115, v93, v97, v115
  v_dot2_f32_bf16 v100, v34, v98, v100
  v_dot2_f32_bf16 v101, v38, v98, v101
  v_dot2_f32_bf16 v102, v42, v98, v102
  v_dot2_f32_bf16 v103, v46, v98, v103
  v_dot2_f32_bf16 v104, v50, v98, v104
  v_dot2_f32_bf16 v105, v54, v98, v105
  v_dot2_f32_bf16 v106, v58, v98, v106
  v_dot2_f32_bf16 v107, v62, v98, v107
  v_dot2_f32_bf16 v108, v66, v98, v108
  v_dot2_f32_bf16 v109, v70, v98, v109
  v_dot2_f32_bf16 v110, v74, v98, v110
  v_dot2_f32_bf16 v111, v78, v98, v111
  v_dot2_f32_bf16 v112, v82, v98, v112
  v_dot2_f32_bf16 v113, v86, v98, v113
  v_dot2_f32_bf16 v114, v90, v98, v114
  v_dot2_f32_bf16 v115, v94, v98, v115
  v_dot2_f32_bf16 v100, v35, v99, v100
  v_dot2_f32_bf16 v101, v39, v99, v101
  v_dot2_f32_bf16 v102, v43, v99, v102
  v_dot2_f32_bf16 v103, v47, v99, v103
  v_dot2_f32_bf16 v104, v51, v99, v104
  v_dot2_f32_bf16 v105, v55, v99, v105
  v_dot2_f32_bf16 v106, v59, v99, v106
  v_dot2_f32_bf16 v107, v63, v99, v107
  v_dot2_f32_bf16 v108, v67, v99, v108
  v_dot2_f32_bf16 v109, v71, v99, v109
  v_dot2_f32_bf16 v110, v75, v99, v110
  v_dot2_f32_bf16 v111, v79, v99, v111
  v_dot2_f32_bf16 v112, v83, v99, v112
  v_dot2_f32_bf16 v113, v87, v99, v113
  v_dot2_f32_bf16 v114, v91, v99, v114
  v_dot2_f32_bf16 v115, v95, v99, v115
  v_add_f32_dpp v100, v100, v100 row_shr:1 row_mask:0xf bank_mask:0xf bound_ctrl:0
  v_add_f32_dpp v101, v101, v101 row_shr:1 row_mask:0xf bank_mask:0xf bound_ctrl:0
  v_add_f32_dpp v102, v102, v102 row_shr:1 row_mask:0xf bank_mask:0xf bound_ctrl:0
  v_add_f32_dpp v103, v103, v103 row_shr:1 row_mask:0xf bank_mask:0xf bound_ctrl:0
  v_add_f32_dpp v104, v104, v104 row_shr:1 row_mask:0xf bank_mask:0xf bound_ctrl:0
  v_add_f32_dpp v105, v105, v105 row_shr:1 row_mask:0xf bank_mask:0xf bound_ctrl:0
  v_add_f32_dpp v106, v106, v106 row_shr:1 row_mask:0xf bank_mask:0xf bound_ctrl:0
  v_add_f32_dpp v107, v107, v107 row_shr:1 row_mask:0xf bank_mask:0xf bound_ctrl:0
  v_add_f32_dpp v108, v108, v108 row_shr:1 row_mask:0xf bank_mask:0xf bound_ctrl:0
  v_add_f32_dpp v109, v109, v109 row_shr:1 row_mask:0xf bank_mask:0xf bound_ctrl:0
  v_add_f32_dpp v110, v110, v110 row_shr:1 row_mask:0xf bank_mask:0xf bound_ctrl:0
  v_add_f32_dpp v111, v111, v111 row_shr:1 row_mask:0xf bank_mask:0xf bound_ctrl:0
  v_add_f32_dpp v112, v112, v112 row_shr:1 row_mask:0xf bank_mask:0xf bound_ctrl:0
  v_add_f32_dpp v113, v113, v113 row_shr:1 row_mask:0xf bank_mask:0xf bound_ctrl:0
  v_add_f32_dpp v114, v114, v114 row_shr:1 row_mask:0xf bank_mask:0xf bound_ctrl:0
  v_add_f32_dpp v115, v115, v115 row_shr:1 row_mask:0xf bank_mask:0xf bound_ctrl:0
  v_add_f32_dpp v100, v100, v100 row_shr:2 row_mask:0xf bank_mask:0xf bound_ctrl:0
  v_add_f32_dpp v101, v101, v101 row_shr:2 row_mask:0xf bank_mask:0xf bound_ctrl:0
  v_add_f32_dpp v102, v102, v102 row_shr:2 row_mask:0xf bank_mask:0xf bound_ctrl:0
  v_add_f32_dpp v103, v103, v103 row_shr:2 row_mask:0xf bank_mask:0xf bound_ctrl:0
  v_add_f32_dpp v104, v104, v104 row_shr:2 row_mask:0xf bank_mask:0xf bound_ctrl:0
  v_add_f32_dpp v105, v105, v105 row_shr:2 row_mask:0xf bank_mask:0xf bound_ctrl:0
  v_add_f32_dpp v106, v106, v106 row_shr:2 row_mask:0xf bank_mask:0xf bound_ctrl:0
  v_add_f32_dpp v107, v107, v107 row_shr:2 row_mask:0xf bank_mask:0xf bound_ctrl:0
  v_add_f32_dpp v108, v108, v108 row_shr:2 row_mask:0xf bank_mask:0xf bound_ctrl:0
  v_add_f32_dpp v109, v109, v109 row_shr:2 row_mask:0xf bank_mask:0xf bound_ctrl:0
  v_add_f32_dpp v110, v110, v110 row_shr:2 row_mask:0xf bank_mask:0xf bound_ctrl:0
  v_add_f32_dpp v111, v111, v111 row_shr:2 row_mask:0xf bank_mask:0xf bound_ctrl:0
  v_add_f32_dpp v112, v112, v112 row_shr:2 row_mask:0xf bank_mask:0xf bound_ctrl:0
  v_add_f32_dpp v113, v113, v113 row_shr:2 row_mask:0xf bank_mask:0xf bound_ctrl:0
  v_add_f32_dpp v114, v114, v114 row_shr:2 row_mask:0xf bank_mask:0xf bound_ctrl:0
  v_add_f32_dpp v115, v115, v115 row_shr:2 row_mask:0xf bank_mask:0xf bound_ctrl:0
  v_add_f32_dpp v100, v100, v100 row_shr:4 row_mask:0xf bank_mask:0xf bound_ctrl:0
  v_add_f32_dpp v101, v101, v101 row_shr:4 row_mask:0xf bank_mask:0xf bound_ctrl:0
  v_add_f32_dpp v102, v102, v102 row_shr:4 row_mask:0xf bank_mask:0xf bound_ctrl:0
  v_add_f32_dpp v103, v103, v103 row_shr:4 row_mask:0xf bank_mask:0xf bound_ctrl:0
  v_add_f32_dpp v104, v104, v104 row_shr:4 row_mask:0xf bank_mask:0xf bound_ctrl:0
  v_add_f32_dpp v105, v105, v105 row_shr:4 row_mask:0xf bank_mask:0xf bound_ctrl:0
  v_add_f32_dpp v106, v106, v106 row_shr:4 row_mask:0xf bank_mask:0xf bound_ctrl:0
  v_add_f32_dpp v107, v107, v107 row_shr:4 row_mask:0xf bank_mask:0xf bound_ctrl:0
  v_add_f32_dpp v108, v108, v108 row_shr:4 row_mask:0xf bank_mask:0xf bound_ctrl:0
  v_add_f32_dpp v109, v109, v109 row_shr:4 row_mask:0xf bank_mask:0xf bound_ctrl:0
  v_add_f32_dpp v110, v110, v110 row_shr:4 row_mask:0xf bank_mask:0xf bound_ctrl:0
  v_add_f32_dpp v111, v111, v111 row_shr:4 row_mask:0xf bank_mask:0xf bound_ctrl:0
  v_add_f32_dpp v112, v112, v112 row_shr:4 row_mask:0xf bank_mask:0xf bound_ctrl:0
  v_add_f32_dpp v113, v113, v113 row_shr:4 row_mask:0xf bank_mask:0xf bound_ctrl:0
  v_add_f32_dpp v114, v114, v114 row_shr:4 row_mask:0xf bank_mask:0xf bound_ctrl:0
  v_add_f32_dpp v115, v115, v115 row_shr:4 row_mask:0xf bank_mask:0xf bound_ctrl:0
  v_add_f32_dpp v100, v100, v100 row_shr:8 row_mask:0xf bank_mask:0xf bound_ctrl:0
  v_add_f32_dpp v101, v101, v101 row_shr:8 row_mask:0xf bank_mask:0xf bound_ctrl:0
  v_add_f32_dpp v102, v102, v102 row_shr:8 row_mask:0xf bank_mask:0xf bound_ctrl:0
  v_add_f32_dpp v103, v103, v103 row_shr:8 row_mask:0xf bank_mask:0xf bound_ctrl:0
  v_add_f32_dpp v104, v104, v104 row_shr:8 row_mask:0xf bank_mask:0xf bound_ctrl:0
  v_add_f32_dpp v105, v105, v105 row_shr:8 row_mask:0xf bank_mask:0xf bound_ctrl:0
  v_add_f32_dpp v106, v106, v106 row_shr:8 row_mask:0xf bank_mask:0xf bound_ctrl:0
  v_add_f32_dpp v107, v107, v107 row_shr:8 row_mask:0xf bank_mask:0xf bound_ctrl:0
  v_add_f32_dpp v108, v108, v108 row_shr:8 row_mask:0xf bank_mask:0xf bound_ctrl:0
  v_add_f32_dpp v109, v109, v109 row_shr:8 row_mask:0xf bank_mask:0xf bound_ctrl:0
  v_add_f32_dpp v110, v110, v110 row_shr:8 row_mask:0xf bank_mask:0xf bound_ctrl:0
  v_add_f32_dpp v111, v111, v111 row_shr:8 row_mask:0xf bank_mask:0xf bound_ctrl:0
  v_add_f32_dpp v112, v112, v112 row_shr:8 row_mask:0xf bank_mask:0xf bound_ctrl:0
  v_add_f32_dpp v113, v113, v113 row_shr:8 row_mask:0xf bank_mask:0xf bound_ctrl:0
  v_add_f32_dpp v114, v114, v114 row_shr:8 row_mask:0xf bank_mask:0xf bound_ctrl:0
  v_add_f32_dpp v115, v115, v115 row_shr:8 row_mask:0xf bank_mask:0xf bound_ctrl:0
  v_add_f32_dpp v100, v100, v100 row_bcast:15 row_mask:0xa bank_mask:0xf
  v_add_f32_dpp v101, v101, v101 row_bcast:15 row_mask:0xa bank_mask:0xf
  v_add_f32_dpp v102, v102, v102 row_bcast:15 row_mask:0xa bank_mask:0xf
  v_add_f32_dpp v103, v103, v103 row_bcast:15 row_mask:0xa bank_mask:0xf
  v_add_f32_dpp v104, v104, v104 row_bcast:15 row_mask:0xa bank_mask:0xf
  v_add_f32_dpp v105, v105, v105 row_bcast:15 row_mask:0xa bank_mask:0xf
  v_add_f32_dpp v106, v106, v106 row_bcast:15 row_mask:0xa bank_mask:0xf
  v_add_f32_dpp v107, v107, v107 row_bcast:15 row_mask:0xa bank_mask:0xf
  v_add_f32_dpp v108, v108, v108 row_bcast:15 row_mask:0xa bank_mask:0xf
  v_add_f32_dpp v109, v109, v109 row_bcast:15 row_mask:0xa bank_mask:0xf
  v_add_f32_dpp v110, v110, v110 row_bcast:15 row_mask:0xa bank_mask:0xf
  v_add_f32_dpp v111, v111, v111 row_bcast:15 row_mask:0xa bank_mask:0xf
  v_add_f32_dpp v112, v112, v112 row_bcast:15 row_mask:0xa bank_mask:0xf
  v_add_f32_dpp v113, v113, v113 row_bcast:15 row_mask:0xa bank_mask:0xf
  v_add_f32_dpp v114, v114, v114 row_bcast:15 row_mask:0xa bank_mask:0xf
  v_add_f32_dpp v115, v115, v115 row_bcast:15 row_mask:0xa bank_mask:0xf
  v_add_f32_dpp v100, v100, v100 row_bcast:31 row_mask:0xc bank_mask:0xf
  v_add_f32_dpp v101, v101, v101 row_bcast:31 row_mask:0xc bank_mask:0xf
  v_add_f32_dpp v102, v102, v102 row_bcast:31 row_mask:0xc bank_mask:0xf
  v_add_f32_dpp v103, v103, v103 row_bcast:31 row_mask:0xc bank_mask:0xf
  v_add_f32_dpp v104, v104, v104 row_bcast:31 row_mask:0xc bank_mask:0xf
  v_add_f32_dpp v105, v105, v105 row_bcast:31 row_mask:0xc bank_mask:0xf
  v_add_f32_dpp v106, v106, v106 row_bcast:31 row_mask:0xc bank_mask:0xf
  v_add_f32_dpp v107, v107, v107 row_bcast:31 row_mask:0xc bank_mask:0xf
  v_add_f32_dpp v108, v108, v108 row_bcast:31 row_mask:0xc bank_mask:0xf
  v_add_f32_dpp v109, v109, v109 row_bcast:31 row_mask:0xc bank_mask:0xf
  v_add_f32_dpp v110, v110, v110 row_bcast:31 row_mask:0xc bank_mask:0xf
  v_add_f32_dpp v111, v111, v111 row_bcast:31 row_mask:0xc bank_mask:0xf
  v_add_f32_dpp v112, v112, v112 row_bcast:31 row_mask:0xc bank_mask:0xf
  v_add_f32_dpp v113, v113, v113 row_bcast:31 row_mask:0xc bank_mask:0xf
  v_add_f32_dpp v114, v114, v114 row_bcast:31 row_mask:0xc bank_mask:0xf
  v_add_f32_dpp v115, v115, v115 row_bcast:31 row_mask:0xc bank_mask:0xf
  v_mov_b32 v116, 0
  v_readlane_b32 s74, v100, 63
  s_nop 3
  v_writelane_b32 v116, s74, 0
  v_readlane_b32 s75, v101, 63
  s_nop 3
  v_writelane_b32 v116, s75, 1
  v_readlane_b32 s74, v102, 63
  s_nop 3
  v_writelane_b32 v116, s74, 2
  v_readlane_b32 s75, v103, 63
  s_nop 3
  v_writelane_b32 v116, s75, 3
  v_readlane_b32 s74, v104, 63
  s_nop 3
  v_writelane_b32 v116, s74, 4
  v_readlane_b32 s75, v105, 63
  s_nop 3
  v_writelane_b32 v116, s75, 5
  v_readlane_b32 s74, v106, 63
  s_nop 3
  v_writelane_b32 v116, s74, 6
  v_readlane_b32 s75, v107, 63
  s_nop 3
  v_writelane_b32 v116, s75, 7
  v_readlane_b32 s74, v108, 63
  s_nop 3
  v_writelane_b32 v116, s74, 8
  v_readlane_b32 s75, v109, 63
  s_nop 3
  v_writelane_b32 v116, s75, 9
  v_readlane_b32 s74, v110, 63
  s_nop 3
  v_writelane_b32 v116, s74, 10
  v_readlane_b32 s75, v111, 63
  s_nop 3
  v_writelane_b32 v116, s75, 11
  v_readlane_b32 s74, v112, 63
  s_nop 3
  v_writelane_b32 v116, s74, 12
  v_readlane_b32 s75, v113, 63
  s_nop 3
  v_writelane_b32 v116, s75, 13
  v_readlane_b32 s74, v114, 63
  s_nop 3
  v_writelane_b32 v116, s74, 14
  v_readlane_b32 s75, v115, 63
  s_nop 3
  v_writelane_b32 v116, s75, 15
  v_mul_f32 v116, 0xbfb8aa3b, v116
  v_exp_f32 v116, v116
  s_nop 0
  v_add_f32 v116, 1.0, v116
  v_rcp_f32 v116, v116
  s_lshl_b32 s71, s86, 2
  s_add_u32 s71, s71, 16384
  v_lshlrev_b32 v128, 2, v1
  s_mov_b64 exec, 0xffff
  buffer_store_dword v116, v128, s[52:55], s71 offen sc1
  s_mov_b64 exec, -1
  v_mov_b32 v151, 32
  v_mov_b32 v152, 1
  buffer_load_dword v150, v151, s[60:63], 0 offen sc1
  s_waitcnt vmcnt(0)
  v_cmp_lt_u32 vcc, v150, v152
  s_cbranch_vccz L_pd_45
  s_mov_b32 s88, 0
L_pl_46:
  s_sleep 8
  buffer_load_dword v150, v151, s[60:63], 0 offen sc1
  s_waitcnt vmcnt(0)
  s_add_u32 s88, s88, 1
  s_cmp_gt_u32 s88, 0x20000
  s_cbranch_scc1 L_pd_45
  v_cmp_lt_u32 vcc, v150, v152
  s_cbranch_vccnz L_pl_46
L_pd_45:
  v_mov_b32 v6, 163424
  v_mov_b32 v7, 1
  s_mov_b64 exec, 1
  ds_add_rtn_u32 v8, v6, v7
  s_waitcnt lgkmcnt(0)
  s_mov_b64 exec, -1
  v_readfirstlane_b32 s82, v8
  s_nop 0
  s_cmp_lg_u32 s82, 3
  s_cbranch_scc1 L_g_47
  s_mov_b64 exec, 1
  s_lshl_b32 s78, s65, 2
  s_add_u32 s78, s78, s66
  s_sub_u32 s78, s78, 28
  s_lshl_b32 s78, s78, 7
  s_add_u32 s78, s78, 1136
  v_mov_b32 v3, 1
  v_mov_b32 v4, s78
  buffer_store_dword v3, v4, s[52:55], 0 offen sc1
  s_mov_b64 exec, -1
L_g_47:
  s_waitcnt vmcnt(0)
  s_add_u32 m0, s89, 0
  s_lshl_b32 s87, s4, 4
  buffer_load_dwordx4 v144, s[48:51], s87 offen offset:0 lds
  buffer_load_dwordx4 v145, s[48:51], s87 offen offset:1024 lds
  s_add_u32 m0, s89, 2048
  s_lshl_b32 s87, s5, 4
  buffer_load_dwordx4 v144, s[48:51], s87 offen offset:0 lds
  buffer_load_dwordx4 v145, s[48:51], s87 offen offset:1024 lds
  s_add_u32 m0, s89, 4096
  s_lshl_b32 s87, s6, 4
  buffer_load_dwordx4 v144, s[48:51], s87 offen offset:0 lds
  buffer_load_dwordx4 v145, s[48:51], s87 offen offset:1024 lds
  s_add_u32 m0, s89, 6144
  s_lshl_b32 s87, s7, 4
  buffer_load_dwordx4 v144, s[48:51], s87 offen offset:0 lds
  buffer_load_dwordx4 v145, s[48:51], s87 offen offset:1024 lds
L_join:
  s_add_u32 m0, s89, 8192
  s_lshl_b32 s87, s8, 4
  buffer_load_dwordx4 v144, s[48:51], s87 offen offset:0 lds
  buffer_load_dwordx4 v145, s[48:51], s87 offen offset:1024 lds
  s_add_u32 m0, s89, 10240
  s_lshl_b32 s87, s9, 4
  buffer_load_dwordx4 v144, s[48:51], s87 offen offset:0 lds
  buffer_load_dwordx4 v145, s[48:51], s87 offen offset:1024 lds
  s_add_u32 m0, s89, 12288
  s_lshl_b32 s87, s10, 4
  buffer_load_dwordx4 v144, s[48:51], s87 offen offset:0 lds
  buffer_load_dwordx4 v145, s[48:51], s87 offen offset:1024 lds
  s_add_u32 m0, s89, 14336
  s_lshl_b32 s87, s11, 4
  buffer_load_dwordx4 v144, s[48:51], s87 offen offset:0 lds
  buffer_load_dwordx4 v145, s[48:51], s87 offen offset:1024 lds
  s_add_u32 m0, s89, 16384
  s_lshl_b32 s87, s12, 4
  buffer_load_dwordx4 v144, s[48:51], s87 offen offset:0 lds
  buffer_load_dwordx4 v145, s[48:51], s87 offen offset:1024 lds
  s_add_u32 m0, s89, 18432
  s_lshl_b32 s87, s13, 4
  buffer_load_dwordx4 v144, s[48:51], s87 offen offset:0 lds
  buffer_load_dwordx4 v145, s[48:51], s87 offen offset:1024 lds
  s_add_u32 m0, s89, 20480
  s_lshl_b32 s87, s14, 4
  buffer_load_dwordx4 v144, s[48:51], s87 offen offset:0 lds
  buffer_load_dwordx4 v145, s[48:51], s87 offen offset:1024 lds
  s_add_u32 m0, s89, 22528
  s_lshl_b32 s87, s15, 4
  buffer_load_dwordx4 v144, s[48:51], s87 offen offset:0 lds
  buffer_load_dwordx4 v145, s[48:51], s87 offen offset:1024 lds
  s_waitcnt vmcnt(22)
  ds_read_b64_tr_b16 v[64:65], v148 offset:0
  ds_read_b64_tr_b16 v[66:67], v148 offset:1024
  ds_read_b64_tr_b16 v[68:69], v149 offset:0
  ds_read_b64_tr_b16 v[70:71], v149 offset:1024
  s_waitcnt vmcnt(20)
  ds_read_b64_tr_b16 v[72:73], v148 offset:2048
  ds_read_b64_tr_b16 v[74:75], v148 offset:3072
  ds_read_b64_tr_b16 v[76:77], v149 offset:2048
  ds_read_b64_tr_b16 v[78:79], v149 offset:3072
  s_waitcnt vmcnt(18)
  ds_read_b64_tr_b16 v[80:81], v148 offset:4096
  ds_read_b64_tr_b16 v[82:83], v148 offset:5120
  ds_read_b64_tr_b16 v[84:85], v149 offset:4096
  ds_read_b64_tr_b16 v[86:87], v149 offset:5120
  s_waitcnt vmcnt(16)
  ds_read_b64_tr_b16 v[88:89], v148 offset:6144
  ds_read_b64_tr_b16 v[90:91], v148 offset:7168
  ds_read_b64_tr_b16 v[92:93], v149 offset:6144
  ds_read_b64_tr_b16 v[94:95], v149 offset:7168
  s_waitcnt vmcnt(14)
  ds_read_b64_tr_b16 a[0:1], v148 offset:8192
  ds_read_b64_tr_b16 a[2:3], v148 offset:9216
  ds_read_b64_tr_b16 a[4:5], v149 offset:8192
  ds_read_b64_tr_b16 a[6:7], v149 offset:9216
  s_waitcnt vmcnt(12)
  ds_read_b64_tr_b16 a[8:9], v148 offset:10240
  ds_read_b64_tr_b16 a[10:11], v148 offset:11264
  ds_read_b64_tr_b16 a[12:13], v149 offset:10240
  ds_read_b64_tr_b16 a[14:15], v149 offset:11264
  s_waitcnt vmcnt(10)
  ds_read_b64_tr_b16 a[16:17], v148 offset:12288
  ds_read_b64_tr_b16 a[18:19], v148 offset:13312
  ds_read_b64_tr_b16 a[20:21], v149 offset:12288
  ds_read_b64_tr_b16 a[22:23], v149 offset:13312
  s_waitcnt vmcnt(8)
  ds_read_b64_tr_b16 a[24:25], v148 offset:14336
  ds_read_b64_tr_b16 a[26:27], v148 offset:15360
  ds_read_b64_tr_b16 a[28:29], v149 offset:14336
  ds_read_b64_tr_b16 a[30:31], v149 offset:15360
  s_waitcnt lgkmcnt(0)
  s_add_u32 m0, s89, 0
  s_lshl_b32 s87, s16, 4
  buffer_load_dwordx4 v144, s[48:51], s87 offen offset:0 lds
  buffer_load_dwordx4 v145, s[48:51], s87 offen offset:1024 lds
  s_add_u32 m0, s89, 2048
  s_lshl_b32 s87, s17, 4
  buffer_load_dwordx4 v144, s[48:51], s87 offen offset:0 lds
  buffer_load_dwordx4 v145, s[48:51], s87 offen offset:1024 lds
  s_add_u32 m0, s89, 4096
  s_lshl_b32 s87, s18, 4
  buffer_load_dwordx4 v144, s[48:51], s87 offen offset:0 lds
  buffer_load_dwordx4 v145, s[48:51], s87 offen offset:1024 lds
  s_add_u32 m0, s89, 6144
  s_lshl_b32 s87, s19, 4
  buffer_load_dwordx4 v144, s[48:51], s87 offen offset:0 lds
  buffer_load_dwordx4 v145, s[48:51], s87 offen offset:1024 lds
  s_lshl_b32 s78, s95, 7
  s_add_u32 s78, s78, 1024
  v_min_u32 v154, 28, v1
  v_lshl_add_u32 v154, v154, 2, s78
  v_mov_b32 v155, 1
  s_cmp_lg_u32 s64, 0
  s_cbranch_scc1 L_g_48
  buffer_load_dword v153, v154, s[52:55], 0 offen sc1
L_g_48:
  s_add_u32 m0, s89, 8192
  s_lshl_b32 s87, s20, 4
  buffer_load_dwordx4 v144, s[48:51], s87 offen offset:0 lds
  buffer_load_dwordx4 v145, s[48:51], s87 offen offset:1024 lds
  s_add_u32 m0, s89, 10240
  s_lshl_b32 s87, s21, 4
  buffer_load_dwordx4 v144, s[48:51], s87 offen offset:0 lds
  buffer_load_dwordx4 v145, s[48:51], s87 offen offset:1024 lds
  s_add_u32 m0, s89, 12288
  s_lshl_b32 s87, s22, 4
  buffer_load_dwordx4 v144, s[48:51], s87 offen offset:0 lds
  buffer_load_dwordx4 v145, s[48:51], s87 offen offset:1024 lds
  s_add_u32 m0, s89, 14336
  s_lshl_b32 s87, s23, 4
  buffer_load_dwordx4 v144, s[48:51], s87 offen offset:0 lds
  buffer_load_dwordx4 v145, s[48:51], s87 offen offset:1024 lds
  v_mov_b32 v3, 163492
  s_cmp_lg_u32 s64, 0
  s_cbranch_scc1 L_po_49
  s_waitcnt vmcnt(8)
  v_cmp_lt_u32 vcc, v153, v155
  s_cbranch_vccz L_pd_51
  s_mov_b32 s88, 0
  buffer_load_dword v153, v154, s[52:55], 0 offen sc1
L_pl_52:
  s_sleep 3
  buffer_load_dword v5, v154, s[52:55], 0 offen sc1
  s_waitcnt vmcnt(1)
  v_cmp_lt_u32 vcc, v153, v155
  s_cbranch_vccz L_pr_53
  s_sleep 3
  buffer_load_dword v153, v154, s[52:55], 0 offen sc1
  s_waitcnt vmcnt(1)
  s_add_u32 s88, s88, 1
  s_cmp_gt_u32 s88, 0x10000
  s_cbranch_scc1 L_pr_53
  v_cmp_lt_u32 vcc, v5, v155
  s_cbranch_vccnz L_pl_52
L_pr_53:
  s_waitcnt vmcnt(0)
L_pd_51:
  v_mov_b32 v4, 1
  ds_write_b32 v3, v4
  s_branch L_pj_50
L_po_49:
  s_waitcnt lgkmcnt(0)
  s_mov_b32 s88, 0
L_lw_54:
  ds_read_b32 v4, v3
  s_waitcnt lgkmcnt(0)
  v_readfirstlane_b32 s82, v4
  s_nop 0
  s_cmp_ge_u32 s82, 1
  s_cbranch_scc1 L_ld_55
  s_nop 0
  s_add_u32 s88, s88, 1
  s_cmp_gt_u32 s88, 0x100000
  s_cbranch_scc0 L_lw_54
L_ld_55:
L_pj_50:
  s_waitcnt lgkmcnt(0)
  s_setprio 2
  buffer_load_dwordx4 v[16:19], v146, s[52:55], s4 offen sc1
  buffer_load_dwordx4 v[20:23], v147, s[52:55], s4 offen sc1
  buffer_load_dwordx4 v[24:27], v146, s[52:55], s5 offen sc1
  buffer_load_dwordx4 v[28:31], v147, s[52:55], s5 offen sc1
  buffer_load_dwordx4 v[32:35], v146, s[52:55], s6 offen sc1
  buffer_load_dwordx4 v[36:39], v147, s[52:55], s6 offen sc1
  buffer_load_dwordx4 v[40:43], v146, s[52:55], s7 offen sc1
  buffer_load_dwordx4 v[44:47], v147, s[52:55], s7 offen sc1
  buffer_load_dwordx4 v[48:51], v146, s[52:55], s8 offen sc1
  buffer_load_dwordx4 v[52:55], v147, s[52:55], s8 offen sc1
  buffer_load_dwordx4 v[56:59], v146, s[52:55], s9 offen sc1
  buffer_load_dwordx4 v[60:63], v147, s[52:55], s9 offen sc1
  s_waitcnt vmcnt(11)
  v_mfma_f32_32x32x16_bf16 v[128:143], v[64:67], v[16:19], 0
  v_lshlrev_b32 v8, 4, v1
  s_xor_b32 s70, s64, 1
  v_mfma_f32_32x32x16_bf16 a[48:63], v[68:71], v[16:19], 0
  s_xor_b32 s71, s64, 2
  s_xor_b32 s72, s64, 3
  s_waitcnt vmcnt(10)
  v_mfma_f32_32x32x16_bf16 a[64:79], v[64:67], v[20:23], 0
  s_mul_i32 s70, s70, 12288
  s_mul_i32 s71, s71, 12288
  v_mfma_f32_32x32x16_bf16 a[80:95], v[68:71], v[20:23], 0
  s_mul_i32 s72, s72, 12288
  s_add_u32 s70, s70, 98304
  s_waitcnt vmcnt(9)
  v_mfma_f32_32x32x16_bf16 v[128:143], v[72:75], v[24:27], v[128:143]
  s_add_u32 s71, s71, 102400
  s_add_u32 s72, s72, 106496
  buffer_load_dwordx4 v[16:19], v146, s[52:55], s10 offen sc1
  v_mfma_f32_32x32x16_bf16 a[48:63], v[76:79], v[24:27], a[48:63]
  v_add_u32 v121, s70, v8
  v_add_u32 v122, s71, v8
  buffer_load_dwordx4 v[20:23], v147, s[52:55], s10 offen sc1
  s_waitcnt vmcnt(10)
  v_mfma_f32_32x32x16_bf16 a[64:79], v[72:75], v[28:31], a[64:79]
  v_add_u32 v123, s72, v8
  s_mul_i32 s70, s64, 12288
  v_mfma_f32_32x32x16_bf16 a[80:95], v[76:79], v[28:31], a[80:95]
  s_add_u32 s70, s70, 98304
  v_add_u32 v125, s70, v8
  s_waitcnt vmcnt(9)
  v_mfma_f32_32x32x16_bf16 v[128:143], v[80:83], v[32:35], v[128:143]
  v_lshrrev_b32 v124, 3, v1
  v_mul_u32_u24 v124, 144, v124
  buffer_load_dwordx4 v[24:27], v146, s[52:55], s11 offen sc1
  v_mfma_f32_32x32x16_bf16 a[48:63], v[84:87], v[32:35], a[48:63]
  v_and_b32 v8, 7, v1
  v_lshl_add_u32 v124, v8, 4, v124
  buffer_load_dwordx4 v[28:31], v147, s[52:55], s11 offen sc1
  s_waitcnt vmcnt(10)
  v_mfma_f32_32x32x16_bf16 a[64:79], v[80:83], v[36:39], a[64:79]
  s_mul_i32 s70, s64, 2304
  s_add_u32 s70, s70, 147456
  v_mfma_f32_32x32x16_bf16 a[80:95], v[84:87], v[36:39], a[80:95]
  v_add_u32 v124, s70, v124
  v_bfe_u32 v126, v1, 2, 2
  s_waitcnt vmcnt(9)
  v_mfma_f32_32x32x16_bf16 v[128:143], v[88:91], v[40:43], v[128:143]
  v_lshrrev_b32 v8, 5, v1
  v_lshl_add_u32 v126, v8, 2, v126
  buffer_load_dwordx4 v[32:35], v146, s[52:55], s12 offen sc1
  v_mfma_f32_32x32x16_bf16 a[48:63], v[92:95], v[40:43], a[48:63]
  s_and_b32 s70, s64, 1
  s_lshl_b32 s71, s70, 5
  buffer_load_dwordx4 v[36:39], v147, s[52:55], s12 offen sc1
  s_waitcnt vmcnt(10)
  v_mfma_f32_32x32x16_bf16 a[64:79], v[88:91], v[44:47], a[64:79]
  v_add_u32 v126, s71, v126
  v_mul_u32_u24 v126, 144, v126
  v_mfma_f32_32x32x16_bf16 a[80:95], v[92:95], v[44:47], a[80:95]
  v_bfe_u32 v9, v1, 4, 1
  v_and_b32 v10, 3, v1
  s_waitcnt vmcnt(9)
  v_mfma_f32_32x32x16_bf16 v[128:143], a[0:3], v[48:51], v[128:143]
  v_lshl_add_u32 v9, v9, 2, v10
  v_lshl_add_u32 v126, v9, 3, v126
  buffer_load_dwordx4 v[40:43], v146, s[52:55], s13 offen sc1
  v_mfma_f32_32x32x16_bf16 a[48:63], a[4:7], v[48:51], a[48:63]
  s_lshr_b32 s71, s64, 1
  s_lshl_b32 s72, s71, 6
  buffer_load_dwordx4 v[44:47], v147, s[52:55], s13 offen sc1
  s_waitcnt vmcnt(10)
  v_mfma_f32_32x32x16_bf16 a[64:79], a[0:3], v[52:55], a[64:79]
  s_add_u32 s72, s72, 147456
  v_add_u32 v126, s72, v126
  v_mfma_f32_32x32x16_bf16 a[80:95], a[4:7], v[52:55], a[80:95]
  s_lshl_b32 s86, s95, 6
  s_lshl_b32 s71, s71, 5
  s_waitcnt vmcnt(9)
  v_mfma_f32_32x32x16_bf16 v[128:143], a[8:11], v[56:59], v[128:143]
  s_add_u32 s86, s86, s71
  s_lshl_b32 s93, s86, 10
  buffer_load_dwordx4 v[48:51], v146, s[52:55], s14 offen sc1
  v_mfma_f32_32x32x16_bf16 a[48:63], a[12:15], v[56:59], a[48:63]
  s_lshl_b32 s71, s96, 7
  s_add_u32 s93, s93, s71
  buffer_load_dwordx4 v[52:55], v147, s[52:55], s14 offen sc1
  s_waitcnt vmcnt(10)
  v_mfma_f32_32x32x16_bf16 a[64:79], a[8:11], v[60:63], a[64:79]
  s_lshl_b32 s70, s70, 6
  s_add_u32 s93, s93, s70
  v_mfma_f32_32x32x16_bf16 a[80:95], a[12:15], v[60:63], a[80:95]
  v_and_b32 v127, 31, v1
  v_lshlrev_b32 v127, 10, v127
  s_waitcnt vmcnt(9)
  v_mfma_f32_32x32x16_bf16 v[128:143], a[16:19], v[16:19], v[128:143]
  v_lshl_add_u32 v127, v8, 4, v127
  buffer_load_dwordx4 v[56:59], v146, s[52:55], s15 offen sc1
  v_mfma_f32_32x32x16_bf16 a[48:63], a[20:23], v[16:19], a[48:63]
  buffer_load_dwordx4 v[60:63], v147, s[52:55], s15 offen sc1
  s_waitcnt vmcnt(10)
  v_mfma_f32_32x32x16_bf16 a[64:79], a[16:19], v[20:23], a[64:79]
  v_mfma_f32_32x32x16_bf16 a[80:95], a[20:23], v[20:23], a[80:95]
  s_waitcnt vmcnt(9)
  v_mfma_f32_32x32x16_bf16 v[128:143], a[24:27], v[24:27], v[128:143]
  ds_read_b64_tr_b16 v[96:97], v148 offset:16384
  ds_read_b64_tr_b16 v[98:99], v148 offset:17408
  buffer_load_dwordx4 v[16:19], v146, s[52:55], s16 offen sc1
  v_mfma_f32_32x32x16_bf16 a[48:63], a[28:31], v[24:27], a[48:63]
  ds_read_b64_tr_b16 v[100:101], v149 offset:16384
  ds_read_b64_tr_b16 v[102:103], v149 offset:17408
  buffer_load_dwordx4 v[20:23], v147, s[52:55], s16 offen sc1
  s_waitcnt vmcnt(10)
  v_mfma_f32_32x32x16_bf16 a[64:79], a[24:27], v[28:31], a[64:79]
  v_mfma_f32_32x32x16_bf16 a[80:95], a[28:31], v[28:31], a[80:95]
  s_waitcnt lgkmcnt(2) vmcnt(9)
  v_mfma_f32_32x32x16_bf16 v[128:143], v[96:99], v[32:35], v[128:143]
  ds_read_b64_tr_b16 v[104:105], v148 offset:18432
  ds_read_b64_tr_b16 v[106:107], v148 offset:19456
  buffer_load_dwordx4 v[24:27], v146, s[52:55], s17 offen sc1
  s_waitcnt lgkmcnt(2)
  v_mfma_f32_32x32x16_bf16 a[48:63], v[100:103], v[32:35], a[48:63]
  ds_read_b64_tr_b16 v[108:109], v149 offset:18432
  ds_read_b64_tr_b16 v[110:111], v149 offset:19456
  buffer_load_dwordx4 v[28:31], v147, s[52:55], s17 offen sc1
  s_waitcnt vmcnt(10)
  v_mfma_f32_32x32x16_bf16 a[64:79], v[96:99], v[36:39], a[64:79]
  v_mfma_f32_32x32x16_bf16 a[80:95], v[100:103], v[36:39], a[80:95]
  s_waitcnt lgkmcnt(2) vmcnt(9)
  v_mfma_f32_32x32x16_bf16 v[128:143], v[104:107], v[40:43], v[128:143]
  ds_read_b64_tr_b16 v[96:97], v148 offset:20480
  ds_read_b64_tr_b16 v[98:99], v148 offset:21504
  buffer_load_dwordx4 v[32:35], v146, s[52:55], s18 offen sc1
  s_waitcnt lgkmcnt(2)
  v_mfma_f32_32x32x16_bf16 a[48:63], v[108:111], v[40:43], a[48:63]
  ds_read_b64_tr_b16 v[100:101], v149 offset:20480
  ds_read_b64_tr_b16 v[102:103], v149 offset:21504
  buffer_load_dwordx4 v[36:39], v147, s[52:55], s18 offen sc1
  s_waitcnt vmcnt(10)
  v_mfma_f32_32x32x16_bf16 a[64:79], v[104:107], v[44:47], a[64:79]
  s_add_u32 m0, s89, 16384
  s_lshl_b32 s87, s24, 4
  buffer_load_dwordx4 v144, s[48:51], s87 offen offset:0 lds
  v_mfma_f32_32x32x16_bf16 a[80:95], v[108:111], v[44:47], a[80:95]
  buffer_load_dwordx4 v145, s[48:51], s87 offen offset:1024 lds
  s_waitcnt lgkmcnt(2) vmcnt(11)
  v_mfma_f32_32x32x16_bf16 v[128:143], v[96:99], v[48:51], v[128:143]
  ds_read_b64_tr_b16 v[104:105], v148 offset:22528
  ds_read_b64_tr_b16 v[106:107], v148 offset:23552
  buffer_load_dwordx4 v[40:43], v146, s[52:55], s19 offen sc1
  s_waitcnt lgkmcnt(2)
  v_mfma_f32_32x32x16_bf16 a[48:63], v[100:103], v[48:51], a[48:63]
  ds_read_b64_tr_b16 v[108:109], v149 offset:22528
  ds_read_b64_tr_b16 v[110:111], v149 offset:23552
  buffer_load_dwordx4 v[44:47], v147, s[52:55], s19 offen sc1
  s_waitcnt vmcnt(12)
  v_mfma_f32_32x32x16_bf16 a[64:79], v[96:99], v[52:55], a[64:79]
  s_add_u32 m0, s89, 18432
  s_lshl_b32 s87, s25, 4
  buffer_load_dwordx4 v144, s[48:51], s87 offen offset:0 lds
  v_mfma_f32_32x32x16_bf16 a[80:95], v[100:103], v[52:55], a[80:95]
  buffer_load_dwordx4 v145, s[48:51], s87 offen offset:1024 lds
  s_waitcnt lgkmcnt(2) vmcnt(13)
  v_mfma_f32_32x32x16_bf16 v[128:143], v[104:107], v[56:59], v[128:143]
  ds_read_b64_tr_b16 v[96:97], v148 offset:0
  ds_read_b64_tr_b16 v[98:99], v148 offset:1024
  buffer_load_dwordx4 v[48:51], v146, s[52:55], s20 offen sc1
  s_waitcnt lgkmcnt(2)
  v_mfma_f32_32x32x16_bf16 a[48:63], v[108:111], v[56:59], a[48:63]
  ds_read_b64_tr_b16 v[100:101], v149 offset:0
  ds_read_b64_tr_b16 v[102:103], v149 offset:1024
  buffer_load_dwordx4 v[52:55], v147, s[52:55], s20 offen sc1
  s_waitcnt vmcnt(14)
  v_mfma_f32_32x32x16_bf16 a[64:79], v[104:107], v[60:63], a[64:79]
  s_add_u32 m0, s89, 20480
  s_lshl_b32 s87, s26, 4
  buffer_load_dwordx4 v144, s[48:51], s87 offen offset:0 lds
  v_mfma_f32_32x32x16_bf16 a[80:95], v[108:111], v[60:63], a[80:95]
  buffer_load_dwordx4 v145, s[48:51], s87 offen offset:1024 lds
  s_waitcnt lgkmcnt(2) vmcnt(15)
  v_mfma_f32_32x32x16_bf16 v[128:143], v[96:99], v[16:19], v[128:143]
  ds_read_b64_tr_b16 v[104:105], v148 offset:2048
  ds_read_b64_tr_b16 v[106:107], v148 offset:3072
  buffer_load_dwordx4 v[56:59], v146, s[52:55], s21 offen sc1
  s_waitcnt lgkmcnt(2)
  v_mfma_f32_32x32x16_bf16 a[48:63], v[100:103], v[16:19], a[48:63]
  ds_read_b64_tr_b16 v[108:109], v149 offset:2048
  ds_read_b64_tr_b16 v[110:111], v149 offset:3072
  buffer_load_dwordx4 v[60:63], v147, s[52:55], s21 offen sc1
  s_waitcnt vmcnt(16)
  v_mfma_f32_32x32x16_bf16 a[64:79], v[96:99], v[20:23], a[64:79]
  s_add_u32 m0, s89, 22528
  s_lshl_b32 s87, s27, 4
  buffer_load_dwordx4 v144, s[48:51], s87 offen offset:0 lds
  v_mfma_f32_32x32x16_bf16 a[80:95], v[100:103], v[20:23], a[80:95]
  buffer_load_dwordx4 v145, s[48:51], s87 offen offset:1024 lds
  s_waitcnt lgkmcnt(2) vmcnt(17)
  v_mfma_f32_32x32x16_bf16 v[128:143], v[104:107], v[24:27], v[128:143]
  ds_read_b64_tr_b16 v[96:97], v148 offset:4096
  ds_read_b64_tr_b16 v[98:99], v148 offset:5120
  buffer_load_dwordx4 v[16:19], v146, s[52:55], s22 offen sc1
  s_waitcnt lgkmcnt(2)
  v_mfma_f32_32x32x16_bf16 a[48:63], v[108:111], v[24:27], a[48:63]
  ds_read_b64_tr_b16 v[100:101], v149 offset:4096
  ds_read_b64_tr_b16 v[102:103], v149 offset:5120
  buffer_load_dwordx4 v[20:23], v147, s[52:55], s22 offen sc1
  s_waitcnt vmcnt(18)
  v_mfma_f32_32x32x16_bf16 a[64:79], v[104:107], v[28:31], a[64:79]
  s_add_u32 m0, s89, 0
  s_lshl_b32 s87, s28, 4
  buffer_load_dwordx4 v144, s[48:51], s87 offen offset:0 lds
  v_mfma_f32_32x32x16_bf16 a[80:95], v[108:111], v[28:31], a[80:95]
  buffer_load_dwordx4 v145, s[48:51], s87 offen offset:1024 lds
  s_waitcnt lgkmcnt(2) vmcnt(19)
  v_mfma_f32_32x32x16_bf16 v[128:143], v[96:99], v[32:35], v[128:143]
  ds_read_b64_tr_b16 v[104:105], v148 offset:6144
  ds_read_b64_tr_b16 v[106:107], v148 offset:7168
  buffer_load_dwordx4 v[24:27], v146, s[52:55], s23 offen sc1
  s_waitcnt lgkmcnt(2)
  v_mfma_f32_32x32x16_bf16 a[48:63], v[100:103], v[32:35], a[48:63]
  ds_read_b64_tr_b16 v[108:109], v149 offset:6144
  ds_read_b64_tr_b16 v[110:111], v149 offset:7168
  buffer_load_dwordx4 v[28:31], v147, s[52:55], s23 offen sc1
  s_waitcnt vmcnt(20)
  v_mfma_f32_32x32x16_bf16 a[64:79], v[96:99], v[36:39], a[64:79]
  s_add_u32 m0, s89, 2048
  s_lshl_b32 s87, s29, 4
  buffer_load_dwordx4 v144, s[48:51], s87 offen offset:0 lds
  v_mfma_f32_32x32x16_bf16 a[80:95], v[100:103], v[36:39], a[80:95]
  buffer_load_dwordx4 v145, s[48:51], s87 offen offset:1024 lds
  s_waitcnt lgkmcnt(2) vmcnt(19)
  v_mfma_f32_32x32x16_bf16 v[128:143], v[104:107], v[40:43], v[128:143]
  ds_read_b64_tr_b16 v[96:97], v148 offset:8192
  ds_read_b64_tr_b16 v[98:99], v148 offset:9216
  buffer_load_dwordx4 v[32:35], v146, s[52:55], s24 offen sc1
  s_waitcnt lgkmcnt(2)
  v_mfma_f32_32x32x16_bf16 a[48:63], v[108:111], v[40:43], a[48:63]
  ds_read_b64_tr_b16 v[100:101], v149 offset:8192
  ds_read_b64_tr_b16 v[102:103], v149 offset:9216
  buffer_load_dwordx4 v[36:39], v147, s[52:55], s24 offen sc1
  s_waitcnt vmcnt(20)
  v_mfma_f32_32x32x16_bf16 a[64:79], v[104:107], v[44:47], a[64:79]
  s_add_u32 m0, s89, 4096
  s_lshl_b32 s87, s30, 4
  buffer_load_dwordx4 v144, s[48:51], s87 offen offset:0 lds
  v_mfma_f32_32x32x16_bf16 a[80:95], v[108:111], v[44:47], a[80:95]
  buffer_load_dwordx4 v145, s[48:51], s87 offen offset:1024 lds
  s_waitcnt lgkmcnt(2) vmcnt(19)
  v_mfma_f32_32x32x16_bf16 v[128:143], v[96:99], v[48:51], v[128:143]
  ds_read_b64_tr_b16 v[104:105], v148 offset:10240
  ds_read_b64_tr_b16 v[106:107], v148 offset:11264
  buffer_load_dwordx4 v[40:43], v146, s[52:55], s25 offen sc1
  s_waitcnt lgkmcnt(2)
  v_mfma_f32_32x32x16_bf16 a[48:63], v[100:103], v[48:51], a[48:63]
  ds_read_b64_tr_b16 v[108:109], v149 offset:10240
  ds_read_b64_tr_b16 v[110:111], v149 offset:11264
  buffer_load_dwordx4 v[44:47], v147, s[52:55], s25 offen sc1
  s_waitcnt vmcnt(20)
  v_mfma_f32_32x32x16_bf16 a[64:79], v[96:99], v[52:55], a[64:79]
  s_add_u32 m0, s89, 6144
  s_lshl_b32 s87, s31, 4
  buffer_load_dwordx4 v144, s[48:51], s87 offen offset:0 lds
  v_mfma_f32_32x32x16_bf16 a[80:95], v[100:103], v[52:55], a[80:95]
  buffer_load_dwordx4 v145, s[48:51], s87 offen offset:1024 lds
  s_waitcnt lgkmcnt(2) vmcnt(19)
  v_mfma_f32_32x32x16_bf16 v[128:143], v[104:107], v[56:59], v[128:143]
  ds_read_b64_tr_b16 v[96:97], v148 offset:12288
  ds_read_b64_tr_b16 v[98:99], v148 offset:13312
  buffer_load_dwordx4 v[48:51], v146, s[52:55], s26 offen sc1
  s_waitcnt lgkmcnt(2)
  v_mfma_f32_32x32x16_bf16 a[48:63], v[108:111], v[56:59], a[48:63]
  ds_read_b64_tr_b16 v[100:101], v149 offset:12288
  ds_read_b64_tr_b16 v[102:103], v149 offset:13312
  buffer_load_dwordx4 v[52:55], v147, s[52:55], s26 offen sc1
  s_waitcnt vmcnt(20)
  v_mfma_f32_32x32x16_bf16 a[64:79], v[104:107], v[60:63], a[64:79]
  v_mfma_f32_32x32x16_bf16 a[80:95], v[108:111], v[60:63], a[80:95]
  s_waitcnt lgkmcnt(2) vmcnt(17)
  v_mfma_f32_32x32x16_bf16 v[128:143], v[96:99], v[16:19], v[128:143]
  ds_read_b64_tr_b16 v[104:105], v148 offset:14336
  ds_read_b64_tr_b16 v[106:107], v148 offset:15360
  buffer_load_dwordx4 v[56:59], v146, s[52:55], s27 offen sc1
  s_waitcnt lgkmcnt(2)
  v_mfma_f32_32x32x16_bf16 a[48:63], v[100:103], v[16:19], a[48:63]
  ds_read_b64_tr_b16 v[108:109], v149 offset:14336
  ds_read_b64_tr_b16 v[110:111], v149 offset:15360
  buffer_load_dwordx4 v[60:63], v147, s[52:55], s27 offen sc1
  s_waitcnt vmcnt(18)
  v_mfma_f32_32x32x16_bf16 a[64:79], v[96:99], v[20:23], a[64:79]
  v_mfma_f32_32x32x16_bf16 a[80:95], v[100:103], v[20:23], a[80:95]
  s_waitcnt lgkmcnt(2) vmcnt(15)
  v_mfma_f32_32x32x16_bf16 v[128:143], v[104:107], v[24:27], v[128:143]
  ds_read_b64_tr_b16 v[96:97], v148 offset:16384
  ds_read_b64_tr_b16 v[98:99], v148 offset:17408
  buffer_load_dwordx4 v[16:19], v146, s[52:55], s28 offen sc1
  s_waitcnt lgkmcnt(2)
  v_mfma_f32_32x32x16_bf16 a[48:63], v[108:111], v[24:27], a[48:63]
  ds_read_b64_tr_b16 v[100:101], v149 offset:16384
  ds_read_b64_tr_b16 v[102:103], v149 offset:17408
  buffer_load_dwordx4 v[20:23], v147, s[52:55], s28 offen sc1
  s_waitcnt vmcnt(16)
  v_mfma_f32_32x32x16_bf16 a[64:79], v[104:107], v[28:31], a[64:79]
  v_mfma_f32_32x32x16_bf16 a[80:95], v[108:111], v[28:31], a[80:95]
  s_waitcnt lgkmcnt(2) vmcnt(13)
  v_mfma_f32_32x32x16_bf16 v[128:143], v[96:99], v[32:35], v[128:143]
  ds_read_b64_tr_b16 v[104:105], v148 offset:18432
  ds_read_b64_tr_b16 v[106:107], v148 offset:19456
  buffer_load_dwordx4 v[24:27], v146, s[52:55], s29 offen sc1
  s_waitcnt lgkmcnt(2)
  v_mfma_f32_32x32x16_bf16 a[48:63], v[100:103], v[32:35], a[48:63]
  ds_read_b64_tr_b16 v[108:109], v149 offset:18432
  ds_read_b64_tr_b16 v[110:111], v149 offset:19456
  buffer_load_dwordx4 v[28:31], v147, s[52:55], s29 offen sc1
  s_waitcnt vmcnt(14)
  v_mfma_f32_32x32x16_bf16 a[64:79], v[96:99], v[36:39], a[64:79]
  v_mfma_f32_32x32x16_bf16 a[80:95], v[100:103], v[36:39], a[80:95]
  s_waitcnt lgkmcnt(2) vmcnt(11)
  v_mfma_f32_32x32x16_bf16 v[128:143], v[104:107], v[40:43], v[128:143]
  ds_read_b64_tr_b16 v[96:97], v148 offset:20480
  ds_read_b64_tr_b16 v[98:99], v148 offset:21504
  buffer_load_dwordx4 v[32:35], v146, s[52:55], s30 offen sc1
  s_waitcnt lgkmcnt(2)
  v_mfma_f32_32x32x16_bf16 a[48:63], v[108:111], v[40:43], a[48:63]
  ds_read_b64_tr_b16 v[100:101], v149 offset:20480
  ds_read_b64_tr_b16 v[102:103], v149 offset:21504
  buffer_load_dwordx4 v[36:39], v147, s[52:55], s30 offen sc1
  s_waitcnt vmcnt(12)
  v_mfma_f32_32x32x16_bf16 a[64:79], v[104:107], v[44:47], a[64:79]
  v_mfma_f32_32x32x16_bf16 a[80:95], v[108:111], v[44:47], a[80:95]
  s_waitcnt lgkmcnt(2) vmcnt(9)
  v_mfma_f32_32x32x16_bf16 v[128:143], v[96:99], v[48:51], v[128:143]
  ds_read_b64_tr_b16 v[104:105], v148 offset:22528
  ds_read_b64_tr_b16 v[106:107], v148 offset:23552
  buffer_load_dwordx4 v[40:43], v146, s[52:55], s31 offen sc1
  s_waitcnt lgkmcnt(2)
  v_mfma_f32_32x32x16_bf16 a[48:63], v[100:103], v[48:51], a[48:63]
  ds_read_b64_tr_b16 v[108:109], v149 offset:22528
  ds_read_b64_tr_b16 v[110:111], v149 offset:23552
  buffer_load_dwordx4 v[44:47], v147, s[52:55], s31 offen sc1
  s_waitcnt vmcnt(10)
  v_mfma_f32_32x32x16_bf16 a[64:79], v[96:99], v[52:55], a[64:79]
  v_mfma_f32_32x32x16_bf16 a[80:95], v[100:103], v[52:55], a[80:95]
  s_lshl_b32 s78, s96, 1
  s_lshr_b32 s79, s95, 4
  s_add_u32 s78, s78, s79
  s_lshl_b32 s78, s78, 8
  s_add_u32 s78, s78, 5120
  v_lshl_add_u32 v157, v1, 2, s78
  v_mov_b32 v158, 1
  s_cmp_lg_u32 s64, 0
  s_cbranch_scc1 L_g_56
  buffer_load_dword v156, v157, s[52:55], 0 offen sc1
L_g_56:
  s_waitcnt lgkmcnt(2) vmcnt(9)
  v_mfma_f32_32x32x16_bf16 v[128:143], v[104:107], v[56:59], v[128:143]
  ds_read_b64_tr_b16 v[96:97], v148 offset:0
  ds_read_b64_tr_b16 v[98:99], v148 offset:1024
  s_waitcnt lgkmcnt(2)
  v_mfma_f32_32x32x16_bf16 a[48:63], v[108:111], v[56:59], a[48:63]
  ds_read_b64_tr_b16 v[100:101], v149 offset:0
  ds_read_b64_tr_b16 v[102:103], v149 offset:1024
  s_waitcnt vmcnt(8)
  v_mfma_f32_32x32x16_bf16 a[64:79], v[104:107], v[60:63], a[64:79]
  v_mfma_f32_32x32x16_bf16 a[80:95], v[108:111], v[60:63], a[80:95]
  s_waitcnt lgkmcnt(2) vmcnt(7)
  v_mfma_f32_32x32x16_bf16 v[128:143], v[96:99], v[16:19], v[128:143]
  ds_read_b64_tr_b16 v[104:105], v148 offset:2048
  ds_read_b64_tr_b16 v[106:107], v148 offset:3072
  s_waitcnt lgkmcnt(2)
  v_mfma_f32_32x32x16_bf16 a[48:63], v[100:103], v[16:19], a[48:63]
  ds_read_b64_tr_b16 v[108:109], v149 offset:2048
  ds_read_b64_tr_b16 v[110:111], v149 offset:3072
  s_waitcnt vmcnt(6)
  v_mfma_f32_32x32x16_bf16 a[64:79], v[96:99], v[20:23], a[64:79]
  v_mfma_f32_32x32x16_bf16 a[80:95], v[100:103], v[20:23], a[80:95]
  s_waitcnt lgkmcnt(2) vmcnt(5)
  v_mfma_f32_32x32x16_bf16 v[128:143], v[104:107], v[24:27], v[128:143]
  ds_read_b64_tr_b16 v[96:97], v148 offset:4096
  ds_read_b64_tr_b16 v[98:99], v148 offset:5120
  s_waitcnt lgkmcnt(2)
  v_mfma_f32_32x32x16_bf16 a[48:63], v[108:111], v[24:27], a[48:63]
  ds_read_b64_tr_b16 v[100:101], v149 offset:4096
  ds_read_b64_tr_b16 v[102:103], v149 offset:5120
  s_waitcnt vmcnt(4)
  v_mfma_f32_32x32x16_bf16 a[64:79], v[104:107], v[28:31], a[64:79]
  v_mfma_f32_32x32x16_bf16 a[80:95], v[108:111], v[28:31], a[80:95]
  v_mov_b32 v3, 163496
  s_cmp_lg_u32 s64, 0
  s_cbranch_scc1 L_po_57
  s_waitcnt vmcnt(0)
  v_cmp_lt_u32 vcc, v156, v158
  s_cbranch_vccz L_pd_59
  s_mov_b32 s88, 0
  buffer_load_dword v156, v157, s[52:55], 0 offen sc1
L_pl_60:
  s_sleep 3
  buffer_load_dword v5, v157, s[52:55], 0 offen sc1
  s_waitcnt vmcnt(1)
  v_cmp_lt_u32 vcc, v156, v158
  s_cbranch_vccz L_pr_61
  s_sleep 3
  buffer_load_dword v156, v157, s[52:55], 0 offen sc1
  s_waitcnt vmcnt(1)
  s_add_u32 s88, s88, 1
  s_cmp_gt_u32 s88, 0x10000
  s_cbranch_scc1 L_pr_61
  v_cmp_lt_u32 vcc, v5, v158
  s_cbranch_vccnz L_pl_60
L_pr_61:
  s_waitcnt vmcnt(0)
L_pd_59:
  v_mov_b32 v4, 1
  ds_write_b32 v3, v4
  s_branch L_pj_58
L_po_57:
  s_waitcnt lgkmcnt(0)
  s_mov_b32 s88, 0
L_lw_62:
  ds_read_b32 v4, v3
  s_waitcnt lgkmcnt(0)
  v_readfirstlane_b32 s82, v4
  s_nop 0
  s_cmp_ge_u32 s82, 1
  s_cbranch_scc1 L_ld_63
  s_nop 0
  s_add_u32 s88, s88, 1
  s_cmp_gt_u32 s88, 0x100000
  s_cbranch_scc0 L_lw_62
L_ld_63:
L_pj_58:
  s_waitcnt lgkmcnt(0)
  s_lshl_b32 s70, s96, 6
  s_lshl_b32 s71, s64, 4
  s_add_u32 s70, s70, s71
  s_lshl_b32 s70, s70, 12
  s_lshl_b32 s71, s95, 7
  s_add_u32 s70, s70, s71
  s_add_u32 s70, s70, 5242880
  s_add_u32 s71, s70, 32768
  v_lshrrev_b32 v8, 3, v1
  v_and_b32 v9, 7, v1
  v_lshlrev_b32 v9, 4, v9
  v_lshl_add_u32 v8, v8, 12, v9
  buffer_load_dwordx4 v[112:115], v8, s[52:55], s70 offen sc1
  buffer_load_dwordx4 v[116:119], v8, s[52:55], s71 offen sc1
  s_lshl_b32 s74, s86, 2
  s_add_u32 s74, s74, 16384
  v_and_b32 v8, 31, v1
  v_lshlrev_b32 v8, 2, v8
  buffer_load_dword v120, v8, s[52:55], s74 offen sc1
  v_mov_b32 v3, 163428
  s_waitcnt lgkmcnt(0)
  s_mov_b32 s88, 0
L_lw_64:
  ds_read_b32 v4, v3
  s_waitcnt lgkmcnt(0)
  v_readfirstlane_b32 s82, v4
  s_nop 0
  s_cmp_ge_u32 s82, 4
  s_cbranch_scc1 L_ld_65
  s_sleep 1
  s_add_u32 s88, s88, 1
  s_cmp_gt_u32 s88, 0x100000
  s_cbranch_scc0 L_lw_64
L_ld_65:
  s_waitcnt vmcnt(6)
  v_mfma_f32_32x32x16_bf16 v[128:143], v[96:99], v[32:35], v[128:143]
  ds_read_b64_tr_b16 v[104:105], v148 offset:6144
  ds_read_b64_tr_b16 v[106:107], v148 offset:7168
  v_mfma_f32_32x32x16_bf16 a[48:63], v[100:103], v[32:35], a[48:63]
  ds_read_b64_tr_b16 v[108:109], v149 offset:6144
  ds_read_b64_tr_b16 v[110:111], v149 offset:7168
  s_waitcnt vmcnt(5)
  v_mfma_f32_32x32x16_bf16 a[64:79], v[96:99], v[36:39], a[64:79]
  v_mfma_f32_32x32x16_bf16 a[80:95], v[100:103], v[36:39], a[80:95]
  s_waitcnt lgkmcnt(2) vmcnt(4)
  v_mfma_f32_32x32x16_bf16 v[128:143], v[104:107], v[40:43], v[128:143]
  s_waitcnt lgkmcnt(0)
  v_mfma_f32_32x32x16_bf16 a[48:63], v[108:111], v[40:43], a[48:63]
  s_waitcnt vmcnt(3)
  v_mfma_f32_32x32x16_bf16 a[64:79], v[104:107], v[44:47], a[64:79]
  v_mfma_f32_32x32x16_bf16 a[80:95], v[108:111], v[44:47], a[80:95]
  s_waitcnt vmcnt(2)
  ds_write_b128 v124, v[112:115]
  s_waitcnt vmcnt(1)
  ds_write_b128 v124, v[116:119] offset:1152
  s_nop 4
  ds_write_b128 v121, a[48:51] offset:0
  ds_write_b128 v121, a[52:55] offset:1024
  ds_write_b128 v121, a[56:59] offset:2048
  ds_write_b128 v121, a[60:63] offset:3072
  ds_write_b128 v122, a[64:67] offset:0
  ds_write_b128 v122, a[68:71] offset:1024
  ds_write_b128 v122, a[72:75] offset:2048
  ds_write_b128 v122, a[76:79] offset:3072
  ds_write_b128 v123, a[80:83] offset:0
  ds_write_b128 v123, a[84:87] offset:1024
  ds_write_b128 v123, a[88:91] offset:2048
  ds_write_b128 v123, a[92:95] offset:3072
  s_waitcnt vmcnt(0)
  v_mov_b32 v10, v120
  v_mov_b32 v11, v120
  s_waitcnt lgkmcnt(0)
  s_barrier
  ds_read_b64_tr_b16 v[64:65], v126 offset:0
  ds_read_b64_tr_b16 v[66:67], v126 offset:1152
  ds_read_b64_tr_b16 v[68:69], v126 offset:2304
  ds_read_b64_tr_b16 v[70:71], v126 offset:3456
  ds_read_b128 v[16:19], v125 offset:0
  ds_read_b128 v[20:23], v125 offset:1024
  ds_read_b128 v[24:27], v125 offset:2048
  ds_read_b128 v[28:31], v125 offset:3072
  ds_read_b128 v[32:35], v125 offset:4096
  ds_read_b128 v[36:39], v125 offset:5120
  ds_read_b128 v[40:43], v125 offset:6144
  ds_read_b128 v[44:47], v125 offset:7168
  ds_read_b128 v[48:51], v125 offset:8192
  ds_read_b128 v[52:55], v125 offset:9216
  ds_read_b128 v[56:59], v125 offset:10240
  ds_read_b128 v[60:63], v125 offset:11264
  s_waitcnt lgkmcnt(15)
  v_lshlrev_b32 v80, 16, v64
  v_and_b32 v81, 0xffff0000, v64
  v_lshlrev_b32 v82, 16, v65
  v_and_b32 v83, 0xffff0000, v65
  s_waitcnt lgkmcnt(14)
  v_lshlrev_b32 v84, 16, v66
  v_and_b32 v85, 0xffff0000, v66
  v_lshlrev_b32 v86, 16, v67
  v_and_b32 v87, 0xffff0000, v67
  s_waitcnt lgkmcnt(13)
  v_lshlrev_b32 v88, 16, v68
  v_and_b32 v89, 0xffff0000, v68
  v_lshlrev_b32 v90, 16, v69
  v_and_b32 v91, 0xffff0000, v69
  s_waitcnt lgkmcnt(12)
  v_lshlrev_b32 v92, 16, v70
  v_and_b32 v93, 0xffff0000, v70
  v_lshlrev_b32 v94, 16, v71
  v_and_b32 v95, 0xffff0000, v71
  s_waitcnt lgkmcnt(11)
  v_pk_add_f32 v[128:129], v[128:129], v[16:17]
  v_pk_add_f32 v[130:131], v[130:131], v[18:19]
  s_waitcnt lgkmcnt(10)
  v_pk_add_f32 v[132:133], v[132:133], v[20:21]
  v_pk_add_f32 v[134:135], v[134:135], v[22:23]
  s_waitcnt lgkmcnt(9)
  v_pk_add_f32 v[136:137], v[136:137], v[24:25]
  v_pk_add_f32 v[138:139], v[138:139], v[26:27]
  s_waitcnt lgkmcnt(8)
  v_pk_add_f32 v[140:141], v[140:141], v[28:29]
  v_pk_add_f32 v[142:143], v[142:143], v[30:31]
  s_waitcnt lgkmcnt(7)
  v_pk_add_f32 v[128:129], v[128:129], v[32:33]
  v_pk_add_f32 v[130:131], v[130:131], v[34:35]
  s_waitcnt lgkmcnt(6)
  v_pk_add_f32 v[132:133], v[132:133], v[36:37]
  v_pk_add_f32 v[134:135], v[134:135], v[38:39]
  s_waitcnt lgkmcnt(5)
  v_pk_add_f32 v[136:137], v[136:137], v[40:41]
  v_pk_add_f32 v[138:139], v[138:139], v[42:43]
  s_waitcnt lgkmcnt(4)
  v_pk_add_f32 v[140:141], v[140:141], v[44:45]
  v_pk_add_f32 v[142:143], v[142:143], v[46:47]
  s_waitcnt lgkmcnt(3)
  v_pk_add_f32 v[128:129], v[128:129], v[48:49]
  v_pk_add_f32 v[130:131], v[130:131], v[50:51]
  s_waitcnt lgkmcnt(2)
  v_pk_add_f32 v[132:133], v[132:133], v[52:53]
  v_pk_add_f32 v[134:135], v[134:135], v[54:55]
  s_waitcnt lgkmcnt(1)
  v_pk_add_f32 v[136:137], v[136:137], v[56:57]
  v_pk_add_f32 v[138:139], v[138:139], v[58:59]
  s_waitcnt lgkmcnt(0)
  v_pk_add_f32 v[140:141], v[140:141], v[60:61]
  v_pk_add_f32 v[142:143], v[142:143], v[62:63]
  v_pk_add_f32 v[80:81], v[80:81], v[128:129] neg_lo:[0,1] neg_hi:[0,1]
  v_pk_add_f32 v[82:83], v[82:83], v[130:131] neg_lo:[0,1] neg_hi:[0,1]
  v_pk_add_f32 v[84:85], v[84:85], v[132:133] neg_lo:[0,1] neg_hi:[0,1]
  v_pk_add_f32 v[86:87], v[86:87], v[134:135] neg_lo:[0,1] neg_hi:[0,1]
  v_pk_add_f32 v[88:89], v[88:89], v[136:137] neg_lo:[0,1] neg_hi:[0,1]
  v_pk_add_f32 v[90:91], v[90:91], v[138:139] neg_lo:[0,1] neg_hi:[0,1]
  v_pk_add_f32 v[92:93], v[92:93], v[140:141] neg_lo:[0,1] neg_hi:[0,1]
  v_pk_add_f32 v[94:95], v[94:95], v[142:143] neg_lo:[0,1] neg_hi:[0,1]
  v_pk_fma_f32 v[128:129], v[80:81], v[10:11], v[128:129]
  v_pk_fma_f32 v[130:131], v[82:83], v[10:11], v[130:131]
  v_pk_fma_f32 v[132:133], v[84:85], v[10:11], v[132:133]
  v_pk_fma_f32 v[134:135], v[86:87], v[10:11], v[134:135]
  v_pk_fma_f32 v[136:137], v[88:89], v[10:11], v[136:137]
  v_pk_fma_f32 v[138:139], v[90:91], v[10:11], v[138:139]
  v_pk_fma_f32 v[140:141], v[92:93], v[10:11], v[140:141]
  v_pk_fma_f32 v[142:143], v[94:95], v[10:11], v[142:143]
  v_cvt_pk_bf16_f32 v72, v128, v129
  v_cvt_pk_bf16_f32 v73, v130, v131
  v_cvt_pk_bf16_f32 v74, v132, v133
  v_cvt_pk_bf16_f32 v75, v134, v135
  v_cvt_pk_bf16_f32 v76, v136, v137
  v_cvt_pk_bf16_f32 v77, v138, v139
  v_cvt_pk_bf16_f32 v78, v140, v141
  v_cvt_pk_bf16_f32 v79, v142, v143
  v_permlane32_swap_b32 v72, v74
  v_permlane32_swap_b32 v73, v75
  v_permlane32_swap_b32 v76, v78
  v_permlane32_swap_b32 v77, v79
  buffer_store_dwordx4 v[72:75], v127, s[56:59], s93 offen
  buffer_store_dwordx4 v[76:79], v127, s[56:59], s93 offen offset:32
  s_branch L_end
L_end:
  s_endpgm

.section .rodata,"a"
.p2align 6
.amdhsa_kernel gated_mix__ssm_conv_s4__dense_activation_mish__prompt_kernel
  .amdhsa_next_free_vgpr 256
  .amdhsa_next_free_sgpr 102
  .amdhsa_accum_offset 160
  .amdhsa_group_segment_fixed_size 0
  .amdhsa_kernarg_size 136
  .amdhsa_user_sgpr_count 2
  .amdhsa_user_sgpr_kernarg_segment_ptr 1
  .amdhsa_system_sgpr_workgroup_id_x 1
.end_amdhsa_kernel
.text
.p2align 8
.type L_gtab,@object
L_gtab:
  .short 1280, 1280, 1280, 1280, 1278, 1278, 1278, 1278, 1278, 1278, 1278, 1270, 1270, 1270, 1270, 1270
  .short 1270, 1270, 1270, 1270, 1262, 1262, 1262, 1262, 1262, 1262, 1262, 1254, 1254, 1254, 1254, 1254
  .short 1254, 1254, 1254, 1254, 1246, 1246, 1246, 1246, 1246, 1246, 1246, 1238, 1238, 1238, 1238, 1238
  .short 1238, 1238, 1238, 1238, 1230, 1230, 1230, 1230, 1230, 1230, 1230, 1222, 1222, 1222, 1222, 1222
  .short 1222, 1222, 1222, 1222, 1214, 1214, 1214, 1214, 1214, 1214, 1214, 1206, 1206, 1206, 1206, 1206
  .short 1206, 1206, 1206, 1206, 1198, 1198, 1198, 1198, 1198, 1198, 1198, 1190, 1190, 1190, 1190, 1190
  .short 1190, 1190, 1190, 1190, 1182, 1182, 1182, 1182, 1182, 1182, 1182, 1174, 1174, 1174, 1174, 1174
  .short 1174, 1174, 1174, 1174, 1166, 1166, 1166, 1166, 1166, 1166, 1166, 1158, 1158, 1158, 1158, 1158
  .short 1158, 1158, 1158, 1158, 1276, 1276, 1276, 1276, 1276, 1276, 1276, 1268, 1268, 1268, 1268, 1268
  .short 1268, 1268, 1268, 1268, 1260, 1260, 1260, 1260, 1260, 1260, 1260, 1252, 1252, 1252, 1252, 1252
  .short 1252, 1252, 1252, 1252, 1244, 1244, 1244, 1244, 1244, 1244, 1244, 1236, 1236, 1236, 1236, 1236
  .short 1236, 1236, 1236, 1236, 1228, 1228, 1228, 1228, 1228, 1228, 1228, 1220, 1220, 1220, 1220, 1220
  .short 1220, 1220, 1220, 1220, 1212, 1212, 1212, 1212, 1212, 1212, 1212, 1204, 1204, 1204, 1204, 1204
  .short 1204, 1204, 1204, 1204, 1196, 1196, 1196, 1196, 1196, 1196, 1196, 1188, 1188, 1188, 1188, 1188
  .short 1188, 1188, 1188, 1188, 1180, 1180, 1180, 1180, 1180, 1180, 1180, 1172, 1172, 1172, 1172, 1172
  .short 1172, 1172, 1172, 1172, 1164, 1164, 1164, 1164, 1164, 1164, 1164, 1156, 1156, 1156, 1156, 1156
  .short 1156, 1156, 1156, 1156, 1274, 1274, 1274, 1274, 1274, 1274, 1274, 1266, 1266, 1266, 1266, 1266
  .short 1266, 1266, 1266, 1266, 1258, 1258, 1258, 1258, 1258, 1258, 1258, 1250, 1250, 1250, 1250, 1250
  .short 1250, 1250, 1250, 1250, 1242, 1242, 1242, 1242, 1242, 1242, 1242, 1234, 1234, 1234, 1234, 1234
  .short 1234, 1234, 1234, 1234, 1226, 1226, 1226, 1226, 1226, 1226, 1226, 1218, 1218, 1218, 1218, 1218
  .short 1218, 1218, 1218, 1218, 1210, 1210, 1210, 1210, 1210, 1210, 1210, 1202, 1202, 1202, 1202, 1202
  .short 1202, 1202, 1202, 1202, 1194, 1194, 1194, 1194, 1194, 1194, 1194, 1186, 1186, 1186, 1186, 1186
  .short 1186, 1186, 1186, 1186, 1178, 1178, 1178, 1178, 1178, 1178, 1178, 1170, 1170, 1170, 1170, 1170
  .short 1170, 1170, 1170, 1170, 1162, 1162, 1162, 1162, 1162, 1162, 1162, 1154, 1154, 1154, 1154, 1154
  .short 1154, 1154, 1154, 1154, 1272, 1272, 1272, 1272, 1272, 1272, 1272, 1264, 1264, 1264, 1264, 1264
  .short 1264, 1264, 1264, 1264, 1256, 1256, 1256, 1256, 1256, 1256, 1256, 1248, 1248, 1248, 1248, 1248
  .short 1248, 1248, 1248, 1248, 1240, 1240, 1240, 1240, 1240, 1240, 1240, 1232, 1232, 1232, 1232, 1232
  .short 1232, 1232, 1232, 1232, 1224, 1224, 1224, 1224, 1224, 1224, 1224, 1216, 1216, 1216, 1216, 1216
  .short 1216, 1216, 1216, 1216, 1208, 1208, 1208, 1208, 1208, 1208, 1208, 1200, 1200, 1200, 1200, 1200
  .short 1200, 1200, 1200, 1200, 1192, 1192, 1192, 1192, 1192, 1192, 1192, 1184, 1184, 1184, 1184, 1184
  .short 1184, 1184, 1184, 1184, 1176, 1176, 1176, 1176, 1176, 1176, 1176, 1168, 1168, 1168, 1168, 1168
  .short 1168, 1168, 1168, 1168, 1160, 1160, 1160, 1160, 1160, 1160, 1160, 1152, 1152, 1152, 1152, 1152
  .short 1152, 1152, 1152, 1152, 1150, 1150, 1150, 1150, 1150, 1150, 1150, 1142, 1142, 1142, 1142, 1142
  .short 1142, 1142, 1142, 1142, 1134, 1134, 1134, 1134, 1134, 1134, 1134, 1126, 1126, 1126, 1126, 1126
  .short 1126, 1126, 1126, 1126, 1118, 1118, 1118, 1118, 1118, 1118, 1118, 1110, 1110, 1110, 1110, 1110
  .short 1110, 1110, 1110, 1110, 1102, 1102, 1102, 1102, 1102, 1102, 1102, 1094, 1094, 1094, 1094, 1094
  .short 1094, 1094, 1094, 1094, 1086, 1086, 1086, 1086, 1086, 1086, 1086, 1078, 1078, 1078, 1078, 1078
  .short 1078, 1078, 1078, 1078, 1070, 1070, 1070, 1070, 1070, 1070, 1070, 1062, 1062, 1062, 1062, 1062
  .short 1062, 1062, 1062, 1062, 1054, 1054, 1054, 1054, 1054, 1054, 1054, 1046, 1046, 1046, 1046, 1046
  .short 1046, 1046, 1046, 1046, 1038, 1038, 1038, 1038, 1038, 1038, 1038, 1030, 1030, 1030, 1030, 1030
  .short 1030, 1030, 1030, 1030, 1148, 1148, 1148, 1148, 1148, 1148, 1148, 1140, 1140, 1140, 1140, 1140
  .short 1140, 1140, 1140, 1140, 1132, 1132, 1132, 1132, 1132, 1132, 1132, 1124, 1124, 1124, 1124, 1124
  .short 1124, 1124, 1124, 1124, 1116, 1116, 1116, 1116, 1116, 1116, 1116, 1108, 1108, 1108, 1108, 1108
  .short 1108, 1108, 1108, 1108, 1100, 1100, 1100, 1100, 1100, 1100, 1100, 1092, 1092, 1092, 1092, 1092
  .short 1092, 1092, 1092, 1092, 1084, 1084, 1084, 1084, 1084, 1084, 1084, 1076, 1076, 1076, 1076, 1076
  .short 1076, 1076, 1076, 1076, 1068, 1068, 1068, 1068, 1068, 1068, 1068, 1060, 1060, 1060, 1060, 1060
  .short 1060, 1060, 1060, 1060, 1052, 1052, 1052, 1052, 1052, 1052, 1052, 1044, 1044, 1044, 1044, 1044
  .short 1044, 1044, 1044, 1044, 1036, 1036, 1036, 1036, 1036, 1036, 1036, 1028, 1028, 1028, 1028, 1028
  .short 1028, 1028, 1028, 1028, 1146, 1146, 1146, 1146, 1146, 1146, 1146, 1138, 1138, 1138, 1138, 1138
  .short 1138, 1138, 1138, 1138, 1130, 1130, 1130, 1130, 1130, 1130, 1130, 1122, 1122, 1122, 1122, 1122
  .short 1122, 1122, 1122, 1122, 1114, 1114, 1114, 1114, 1114, 1114, 1114, 1106, 1106, 1106, 1106, 1106
  .short 1106, 1106, 1106, 1106, 1098, 1098, 1098, 1098, 1098, 1098, 1098, 1090, 1090, 1090, 1090, 1090
  .short 1090, 1090, 1090, 1090, 1082, 1082, 1082, 1082, 1082, 1082, 1082, 1074, 1074, 1074, 1074, 1074
  .short 1074, 1074, 1074, 1074, 1066, 1066, 1066, 1066, 1066, 1066, 1066, 1058, 1058, 1058, 1058, 1058
  .short 1058, 1058, 1058, 1058, 1050, 1050, 1050, 1050, 1050, 1050, 1050, 1042, 1042, 1042, 1042, 1042
  .short 1042, 1042, 1042, 1042, 1034, 1034, 1034, 1034, 1034, 1034, 1034, 1026, 1026, 1026, 1026, 1026
  .short 1026, 1026, 1026, 1026, 1144, 1144, 1144, 1144, 1144, 1144, 1144, 1136, 1136, 1136, 1136, 1136
  .short 1136, 1136, 1136, 1136, 1128, 1128, 1128, 1128, 1128, 1128, 1128, 1120, 1120, 1120, 1120, 1120
  .short 1120, 1120, 1120, 1120, 1112, 1112, 1112, 1112, 1112, 1112, 1112, 1104, 1104, 1104, 1104, 1104
  .short 1104, 1104, 1104, 1104, 1096, 1096, 1096, 1096, 1096, 1096, 1096, 1088, 1088, 1088, 1088, 1088
  .short 1088, 1088, 1088, 1088, 1080, 1080, 1080, 1080, 1080, 1080, 1080, 1072, 1072, 1072, 1072, 1072
  .short 1072, 1072, 1072, 1072, 1064, 1064, 1064, 1064, 1064, 1064, 1064, 1056, 1056, 1056, 1056, 1056
  .short 1056, 1056, 1056, 1056, 1048, 1048, 1048, 1048, 1048, 1048, 1048, 1040, 1040, 1040, 1040, 1040
  .short 1040, 1040, 1040, 1040, 1032, 1032, 1032, 1032, 1032, 1032, 1032, 1024, 1024, 1024, 1024, 1024
  .short 1024, 1024, 1022, 1022, 1022, 1020, 1020, 1020, 1020, 1020, 1014, 1014, 1014, 1012, 1012, 1012
  .short 1012, 1012, 1006, 1006, 1006, 1004, 1004, 1004, 1004, 1004, 998, 998, 998, 996, 996, 996
  .short 996, 996, 990, 990, 990, 988, 988, 988, 988, 988, 982, 982, 982, 980, 980, 980
  .short 980, 980, 974, 974, 974, 972, 972, 972, 972, 972, 966, 966, 966, 964, 964, 964
  .short 964, 964, 958, 958, 958, 956, 956, 956, 956, 956, 950, 950, 950, 948, 948, 948
  .short 948, 948, 942, 942, 942, 940, 940, 940, 940, 940, 934, 934, 934, 932, 932, 932
  .short 932, 932, 926, 926, 926, 924, 924, 924, 924, 924, 918, 918, 918, 916, 916, 916
  .short 916, 916, 910, 910, 910, 908, 908, 908, 908, 908, 902, 902, 902, 900, 900, 900
  .short 900, 900, 1018, 1018, 1018, 1016, 1016, 1016, 1016, 1016, 1010, 1010, 1010, 1008, 1008, 1008
  .short 1008, 1008, 1002, 1002, 1002, 1000, 1000, 1000, 1000, 1000, 994, 994, 994, 992, 992, 992
  .short 992, 992, 986, 986, 986, 984, 984, 984, 984, 984, 978, 978, 978, 976, 976, 976
  .short 976, 976, 970, 970, 970, 968, 968, 968, 968, 968, 962, 962, 962, 960, 960, 960
  .short 960, 960, 954, 954, 954, 952, 952, 952, 952, 952, 946, 946, 946, 944, 944, 944
  .short 944, 944, 938, 938, 938, 936, 936, 936, 936, 936, 930, 930, 930, 928, 928, 928
  .short 928, 928, 922, 922, 922, 920, 920, 920, 920, 920, 914, 914, 914, 912, 912, 912
  .short 912, 912, 906, 906, 906, 904, 904, 904, 904, 904, 898, 898, 898, 896, 896, 896
  .short 896, 896, 894, 894, 894, 892, 892, 892, 892, 892, 886, 886, 886, 884, 884, 884
  .short 884, 884, 878, 878, 878, 876, 876, 876, 876, 876, 870, 870, 870, 868, 868, 868
  .short 868, 868, 862, 862, 862, 860, 860, 860, 860, 860, 854, 854, 854, 852, 852, 852
  .short 852, 852, 846, 846, 846, 844, 844, 844, 844, 844, 838, 838, 838, 836, 836, 836
  .short 836, 836, 830, 830, 830, 828, 828, 828, 828, 828, 822, 822, 822, 820, 820, 820
  .short 820, 820, 814, 814, 814, 812, 812, 812, 812, 812, 806, 806, 806, 804, 804, 804
  .short 804, 804, 798, 798, 798, 796, 796, 796, 796, 796, 790, 790, 790, 788, 788, 788
  .short 788, 788, 782, 782, 782, 780, 780, 780, 780, 780, 774, 774, 774, 772, 772, 772
  .short 772, 772, 890, 890, 890, 888, 888, 888, 888, 888, 882, 882, 882, 880, 880, 880
  .short 880, 880, 874, 874, 874, 872, 872, 872, 872, 872, 866, 866, 866, 864, 864, 864
  .short 864, 864, 858, 858, 858, 856, 856, 856, 856, 856, 850, 850, 850, 848, 848, 848
  .short 848, 848, 842, 842, 842, 840, 840, 840, 840, 840, 834, 834, 834, 832, 832, 832
  .short 832, 832, 826, 826, 826, 824, 824, 824, 824, 824, 818, 818, 818, 816, 816, 816
  .short 816, 816, 810, 810, 810, 808, 808, 808, 808, 808, 802, 802, 802, 800, 800, 800
  .short 800, 800, 794, 794, 794, 792, 792, 792, 792, 792, 786, 786, 786, 784, 784, 784
  .short 784, 784, 778, 778, 778, 776, 776, 776, 776, 776, 770, 770, 770, 768, 768, 768
  .short 768, 766, 764, 764, 764, 762, 760, 760, 760, 758, 756, 756, 756, 754, 752, 752
  .short 752, 750, 748, 748, 748, 746, 744, 744, 744, 742, 740, 740, 740, 738, 736, 736
  .short 736, 734, 732, 732, 732, 730, 728, 728, 728, 726, 724, 724, 724, 722, 720, 720
  .short 720, 718, 716, 716, 716, 714, 712, 712, 712, 710, 708, 708, 708, 706, 704, 704
  .short 704, 702, 700, 700, 700, 698, 696, 696, 696, 694, 692, 692, 692, 690, 688, 688
  .short 688, 686, 684, 684, 684, 682, 680, 680, 680, 678, 676, 676, 676, 674, 672, 672
  .short 672, 670, 668, 668, 668, 666, 664, 664, 664, 662, 660, 660, 660, 658, 656, 656
  .short 656, 654, 652, 652, 652, 650, 648, 648, 648, 646, 644, 644, 644, 642, 640, 640
  .short 640, 638, 636, 636, 636, 634, 632, 632, 632, 630, 628, 628, 628, 626, 624, 624
  .short 624, 622, 620, 620, 620, 618, 616, 616, 616, 614, 612, 612, 612, 610, 608, 608
  .short 608, 606, 604, 604, 604, 602, 600, 600, 600, 598, 596, 596, 596, 594, 592, 592
  .short 592, 590, 588, 588, 588, 586, 584, 584, 584, 582, 580, 580, 580, 578, 576, 576
  .short 576, 574, 572, 572, 572, 570, 568, 568, 568, 566, 564, 564, 564, 562, 560, 560
  .short 560, 558, 556, 556, 556, 554, 552, 552, 552, 550, 548, 548, 548, 546, 544, 544
  .short 544, 542, 540, 540, 540, 538, 536, 536, 536, 534, 532, 532, 532, 530, 528, 528
  .short 528, 526, 524, 524, 524, 522, 520, 520, 520, 518, 516, 516, 516, 514, 512, 512
  .short 510, 508, 506, 504, 382, 380, 378, 376, 502, 500, 498, 496, 374, 372, 370, 368
  .short 494, 492, 490, 488, 366, 364, 362, 360, 486, 484, 482, 480, 358, 356, 354, 352
  .short 478, 476, 474, 472, 350, 348, 346, 344, 470, 468, 466, 464, 342, 340, 338, 336
  .short 462, 460, 458, 456, 334, 332, 330, 328, 454, 452, 450, 448, 326, 324, 322, 320
  .short 446, 444, 442, 440, 318, 316, 314, 312, 438, 436, 434, 432, 310, 308, 306, 304
  .short 430, 428, 426, 424, 302, 300, 298, 296, 422, 420, 418, 416, 294, 292, 290, 288
  .short 414, 412, 410, 408, 286, 284, 282, 280, 406, 404, 402, 400, 278, 276, 274, 272
  .short 398, 396, 394, 392, 270, 268, 266, 264, 390, 388, 386, 384, 262, 260, 258, 256
  .short 254, 252, 250, 248, 126, 124, 122, 120, 246, 244, 242, 240, 118, 116, 114, 112
  .short 238, 236, 234, 232, 110, 108, 106, 104, 230, 228, 226, 224, 102, 100, 98, 96
  .short 222, 220, 218, 216, 94, 92, 90, 88, 214, 212, 210, 208, 86, 84, 82, 80
  .short 206, 204, 202, 200, 78, 76, 74, 72, 198, 196, 194, 192, 70, 68, 66, 64
  .short 190, 188, 186, 184, 62, 60, 58, 56, 182, 180, 178, 176, 54, 52, 50, 48
  .short 174, 172, 170, 168, 46, 44, 42, 40, 166, 164, 162, 160, 38, 36, 34, 32
  .short 158, 156, 154, 152, 30, 28, 26, 24, 150, 148, 146, 144, 22, 20, 18, 16
  .short 142, 140, 138, 136, 14, 12, 10, 8, 134, 132, 130, 128, 6, 4, 2, 0
  .short 1536, 1536, 1536, 1536, 1536, 1536, 1536, 1536, 1536, 1536, 1536, 1536, 1536, 1536, 1536, 1536
L_gtab_end:
.size L_gtab, .-L_gtab
```
